```python
import torch

def _softmax(x, axis=-1):
    return torch.softmax(x, dim=axis)
def _gelu(x):
    return torch.nn.functional.gelu(x, approximate="tanh")
def _silu(x):
    return torch.nn.functional.silu(x)
def _sigmoid(x):
    return torch.sigmoid(x)
def _layernorm(x, axis=-1, eps=1e-5):
    m = x.mean(dim=axis, keepdim=True)
    v = x.var(dim=axis, keepdim=True, unbiased=False)
    return (x - m) / torch.sqrt(v + eps)
def _scatter_add(tgt, idx, src, axis=0):
    return tgt.clone().index_add_(axis, idx, src)
def _segment_sum(src, seg, n):
    out = torch.zeros((n,) + src.shape[1:], dtype=src.dtype)
    return out.index_add_(0, seg, src)
def _pad(x, pw):
    flat = tuple(v for pair in reversed(pw) for v in pair)
    return torch.nn.functional.pad(x, flat)

kernel_name = 'standalone__edge_featured_mpnn_gatedgcn__graph'

def setup_inputs():

    _w = (lambda a: (lambda t: t.to(torch.bfloat16) if t.is_floating_point() else t)(torch.as_tensor(a)))
    N, deg, D, De = 25000, 16, 128, max(0, 1)
    E = N * deg
    return {
        "x": _w((lambda *s: torch.randn(*s, dtype=torch.bfloat16) * 0.4)(N, D)),
        "e_attr": _w((lambda *s: torch.randn(*s, dtype=torch.bfloat16) * 0.8)(E, De)),
        "src": _w((lambda lo, hi, *s: torch.randint(lo, hi, s))(0, N, E).to(torch.int64)),
        "dst": _w((lambda lo, hi, *s: torch.randint(lo, hi, s))(0, N, E).to(torch.int64)),
        "w_a": _w((lambda *s: torch.randn(*s, dtype=torch.bfloat16) * 0.4)(D, D)),
        "w_b": _w((lambda *s: torch.randn(*s, dtype=torch.bfloat16) * 0.4)(D, D)),
        "w_c": _w((lambda *s: torch.randn(*s, dtype=torch.bfloat16) * 0.8)(De, D)),
        "w_u": _w((lambda *s: torch.randn(*s, dtype=torch.bfloat16) * 0.05)(D, D)),
        "w_v": _w((lambda *s: torch.randn(*s, dtype=torch.bfloat16) * 0.05)(D, D)),
    }

def reference(x, e_attr, src, dst, w_a, w_b, w_c, w_u, w_v):
    N, D = x.shape
    hv = x @ w_v
    g = x[dst] @ w_a + x[src] @ w_b + e_attr @ w_c
    eta = _sigmoid(g)
    denom = _segment_sum(eta, dst, N) + 1e-6
    eta_n = eta / denom[dst]
    agg = _segment_sum(eta_n * hv[src], dst, N)
    z = x @ w_u + agg
    relu_z = torch.where(z > 0, z, 0 * z)
    return x + relu_z
```

```asm
; @launch grid=(256,1,1) block=(1024,1,1) lds=163120
.amdgcn_target "amdgcn-amd-amdhsa--gfx950"
.text
.globl standalone__edge_featured_mpnn_gatedgcn__graph_kernel
.p2align 8
.type standalone__edge_featured_mpnn_gatedgcn__graph_kernel,@function
standalone__edge_featured_mpnn_gatedgcn__graph_kernel:
    s_cmp_ge_u32 s2, 256
    s_cbranch_scc1 K_END
    s_load_dwordx16 s[16:31], s[0:1], 0
    s_load_dwordx8 s[32:39], s[0:1], 64
    v_lshrrev_b32 v1, 6, v0
    s_and_b32 s4, s2, 3
    v_readfirstlane_b32 s3, v1
    s_lshr_b32 s5, s2, 2
    v_and_b32 v6, 63, v0
    s_cmp_lg_u32 s3, 15
    s_cbranch_scc1 K_NOCPF
    s_getpc_b64 s[8:9]
K_PC:
    s_mov_b32 s6, K_END-K_PC
    v_lshlrev_b32 v127, 7, v6
    global_load_dword v126, v127, s[8:9]
    v_add_u32 v127, 0x2000, v127
    v_cmp_gt_u32 vcc, s6, v127
    s_mov_b64 exec, vcc
    global_load_dword v126, v127, s[8:9]
    s_mov_b64 exec, -1
K_NOCPF:
    v_mov_b32 v7, 1
    v_mov_b32 v9, 162016
    v_and_b32 v8, 3, v0
    v_lshlrev_b32 v8, 4, v8
    s_sub_u32 s100, s3, 4
    s_cselect_b32 s100, 12, s100
    s_mul_i32 s101, s100, 4608
    s_add_u32 s101, s101, 65600
    v_lshrrev_b32 v22, 3, v6
    v_lshrrev_b32 v21, 4, v6
    v_and_b32 v23, 7, v6
    v_xor_b32 v23, v23, v21
    v_lshlrev_b32 v23, 4, v23
    s_lshl_b32 s6, s100, 5
    v_add_u32 v22, s6, v22
    s_mul_i32 s6, s5, 100096
    v_lshl_add_u32 v21, v22, 8, s6
    v_sub_u32 v22, 390, v22
    s_waitcnt lgkmcnt(0)
    s_lshl_b32 s0, s4, 6
    s_mov_b32 s40, s16
    s_and_b32 s41, s17, 0xffff
    s_mov_b32 s42, 0x61a800
    s_mov_b32 s43, 0x20000
    s_cmp_ge_u32 s3, 4
    s_cbranch_scc1 K_G0
    s_setprio 3
    s_mov_b32 s60, s22
    s_and_b32 s61, s23, 0xffff
    s_mov_b32 s62, 0x186a00
    s_mov_b32 s63, 0x20000
    s_mov_b32 s64, s20
    s_and_b32 s65, s21, 0xffff
    s_mov_b32 s66, 0x186a00
    s_mov_b32 s67, 0x20000
    s_mov_b32 s68, s18
    s_and_b32 s69, s19, 0xffff
    s_mov_b32 s70, 0xc3500
    s_mov_b32 s71, 0x20000
    s_mul_i32 s6, s2, 1568
    v_lshl_add_u32 v2, v0, 2, s6
    v_add_u32 v3, 784, v2
    s_mov_b32 s7, 400000
    v_cmp_gt_u32 vcc, 196, v0
    v_cmp_gt_u32 s[10:11], s7, v2
    v_cmp_gt_u32 s[80:81], s7, v3
    v_lshlrev_b32 v4, 2, v2
    v_lshlrev_b32 v5, 1, v2
    s_and_b64 s[10:11], s[10:11], vcc
    s_and_b64 s[80:81], s[80:81], vcc
    s_mov_b64 exec, vcc
    buffer_load_dwordx4 v[44:47], v4, s[60:63], 0 offen
    buffer_load_dwordx4 v[48:51], v4, s[60:63], 0 offen offset:3136
    buffer_load_dwordx4 v[52:55], v4, s[64:67], 0 offen
    buffer_load_dwordx4 v[56:59], v4, s[64:67], 0 offen offset:3136
    buffer_load_dwordx2 v[60:61], v5, s[68:71], 0 offen
    buffer_load_dwordx2 v[62:63], v5, s[68:71], 0 offen offset:1568
    s_mov_b64 exec, -1
    s_or_b32 s6, s2, s3
    s_cbranch_scc1 K_NOTAG
    s_memrealtime s[8:9]
    s_waitcnt lgkmcnt(0)
    s_lshl_b32 s8, s8, 2
    s_or_b32 s8, s8, 1
    v_mov_b32 v2, s8
    v_mov_b32 v3, 0
    s_mov_b64 exec, 1
    global_store_dword v3, v2, s[36:37] sc1
    s_mov_b64 exec, -1
K_NOTAG:
    s_branch K_C0
K_G0:
K_C0:
    s_movk_i32 s7, 956
    v_lshlrev_b32 v28, 2, v0
    v_add_u32 v28, 158272, v28
    v_lshrrev_b32 v30, 1, v0
    v_mul_u32_u24 v30, 164, v30
    v_and_b32 v31, 1, v0
    v_lshlrev_b32 v31, 2, v31
    v_sub_u32 v30, v30, v31
    v_add_u32 v30, 164, v30
    v_subrev_u32 v29, 808, v0
    v_ashrrev_i32 v29, 31, v29
    v_cmp_gt_u32 s[8:9], s7, v0
    v_and_b32 v30, v29, v30
    s_mov_b64 exec, s[8:9]
    ds_write_b32 v28, v30
    s_mov_b64 exec, -1
    s_waitcnt lgkmcnt(0)
    s_barrier
    s_cmp_lt_u32 s3, 4
    s_cbranch_scc1 K_C2
    s_mov_b32 m0, s101
    s_brev_b32 s7, 1
    v_xor_b32 v108, 0, v23
    v_add_u32 v109, 0, v21
    v_add_u32 v108, v108, v109
    v_subrev_u32 v109, 0, v22
    v_and_or_b32 v108, v109, s7, v108
    buffer_load_dwordx4 v108, s[40:43], 0 offen lds
    s_add_u32 m0, m0, 1024
    v_xor_b32 v108, 64, v23
    v_add_u32 v109, 2048, v21
    v_add_u32 v108, v108, v109
    v_subrev_u32 v109, 8, v22
    v_and_or_b32 v108, v109, s7, v108
    buffer_load_dwordx4 v108, s[40:43], 0 offen lds
    s_add_u32 m0, m0, 1024
    v_xor_b32 v108, 0, v23
    v_add_u32 v109, 4096, v21
    v_add_u32 v108, v108, v109
    v_subrev_u32 v109, 16, v22
    v_and_or_b32 v108, v109, s7, v108
    buffer_load_dwordx4 v108, s[40:43], 0 offen lds
    s_add_u32 m0, m0, 1024
    v_xor_b32 v108, 64, v23
    v_add_u32 v109, 6144, v21
    v_add_u32 v108, v108, v109
    v_subrev_u32 v109, 24, v22
    v_and_or_b32 v108, v109, s7, v108
    buffer_load_dwordx4 v108, s[40:43], 0 offen lds
    s_branch K_C1
K_C2:
    s_cmp_eq_u32 s3, 1
    s_cselect_b32 s44, s32, s26
    s_cselect_b32 s45, s33, s27
    s_cmp_eq_u32 s3, 2
    s_cselect_b32 s44, s24, s44
    s_cselect_b32 s45, s25, s45
    s_cmp_eq_u32 s3, 3
    s_cselect_b32 s44, s30, s44
    s_cselect_b32 s45, s31, s45
    s_and_b32 s45, s45, 0xffff
    s_mov_b32 s46, 32768
    s_mov_b32 s47, 0x20000
    v_lshrrev_b32 v2, 2, v6
    v_lshl_add_u32 v2, v2, 8, v8
    s_lshl_b32 s6, s3, 13
    s_add_u32 m0, s6, 125504
    s_mov_b32 s7, s0
    buffer_load_dwordx4 v2, s[44:47], s7 offen lds
    s_add_u32 m0, m0, 1024
    s_add_u32 s7, s7, 4096
    buffer_load_dwordx4 v2, s[44:47], s7 offen lds
    s_add_u32 m0, m0, 1024
    s_add_u32 s7, s7, 4096
    buffer_load_dwordx4 v2, s[44:47], s7 offen lds
    s_add_u32 m0, m0, 1024
    s_add_u32 s7, s7, 4096
    buffer_load_dwordx4 v2, s[44:47], s7 offen lds
    s_add_u32 m0, m0, 1024
    s_add_u32 s7, s7, 4096
    buffer_load_dwordx4 v2, s[44:47], s7 offen lds
    s_add_u32 m0, m0, 1024
    s_add_u32 s7, s7, 4096
    buffer_load_dwordx4 v2, s[44:47], s7 offen lds
    s_add_u32 m0, m0, 1024
    s_add_u32 s7, s7, 4096
    buffer_load_dwordx4 v2, s[44:47], s7 offen lds
    s_add_u32 m0, m0, 1024
    s_add_u32 s7, s7, 4096
    buffer_load_dwordx4 v2, s[44:47], s7 offen lds
K_C1:
    s_mov_b32 s68, s28
    s_and_b32 s69, s29, 0xffff
    s_mov_b32 s70, 0x100
    s_mov_b32 s71, 0x20000
    buffer_load_dwordx4 v[10:13], v8, s[68:71], s0 offen
    s_mov_b32 s72, 0xffff0000
    s_mov_b32 s73, 0x7fff0000
    s_mov_b32 s74, 0x7fffffff
    s_mov_b32 s75, 0x00800000
    s_mov_b32 s76, 0x07060302
    s_mov_b32 s77, 0xbfb8aa3b
    s_mov_b32 s33, 0
    s_mov_b32 s15, 0
    s_mul_i32 s6, s4, 3203072
    s_add_u32 s48, s38, s6
    s_addc_u32 s49, s39, 0
    s_and_b32 s49, s49, 0xffff
    s_mov_b32 s50, 0x30d400
    s_mov_b32 s51, 0x20000
    s_add_u32 s52, s38, 13631488
    s_addc_u32 s53, s39, 0
    s_and_b32 s53, s53, 0xffff
    s_mov_b32 s54, 0x200000
    s_mov_b32 s55, 0x20000
    s_add_u32 s56, s38, 17825792
    s_addc_u32 s57, s39, 0
    s_and_b32 s57, s57, 0xffff
    s_mov_b32 s58, 0x20000
    s_mov_b32 s59, 0x20000
    s_mov_b32 s60, s34
    s_and_b32 s61, s35, 0xffff
    s_mov_b32 s62, 0x61a800
    s_mov_b32 s63, 0x20000
    s_mov_b32 s68, s36
    s_and_b32 s69, s37, 0xffff
    s_mov_b32 s70, 0x100
    s_mov_b32 s71, 0x20000
    s_add_u32 s64, s38, 19922944
    s_addc_u32 s65, s39, 0
    s_and_b32 s65, s65, 0xffff
    s_mov_b32 s66, 0x8000
    s_mov_b32 s67, 0x20000
    s_cmp_ge_u32 s3, 4
    s_cbranch_scc1 K_GEMM
    s_waitcnt vmcnt(9)
    s_mov_b32 s6, 161760
    s_mov_b32 s7, 4294966905
    v_mul_u32_u24 v2, 42909, v44
    v_lshrrev_b32 v2, 24, v2
    v_mad_i32_i24 v44, v2, s7, v44
    v_and_b32 v76, 62, v2
    v_and_b32 v2, 1, v2
    v_lshlrev_b32 v76, 1, v76
    v_lshl_or_b32 v76, v2, 7, v76
    v_add_u32 v84, s6, v76
    v_mul_u32_u24 v2, 42909, v45
    v_lshrrev_b32 v2, 24, v2
    v_mad_i32_i24 v45, v2, s7, v45
    v_and_b32 v77, 62, v2
    v_and_b32 v2, 1, v2
    v_lshlrev_b32 v77, 1, v77
    v_lshl_or_b32 v77, v2, 7, v77
    v_add_u32 v85, s6, v77
    v_mul_u32_u24 v2, 42909, v46
    v_lshrrev_b32 v2, 24, v2
    v_mad_i32_i24 v46, v2, s7, v46
    v_and_b32 v78, 62, v2
    v_and_b32 v2, 1, v2
    v_lshlrev_b32 v78, 1, v78
    v_lshl_or_b32 v78, v2, 7, v78
    v_add_u32 v86, s6, v78
    v_mul_u32_u24 v2, 42909, v47
    v_lshrrev_b32 v2, 24, v2
    v_mad_i32_i24 v47, v2, s7, v47
    v_and_b32 v79, 62, v2
    v_and_b32 v2, 1, v2
    v_lshlrev_b32 v79, 1, v79
    v_lshl_or_b32 v79, v2, 7, v79
    v_add_u32 v87, s6, v79
    s_mov_b64 exec, s[10:11]
    ds_add_rtn_u32 v64, v84, v7
    ds_add_rtn_u32 v65, v85, v7
    ds_add_rtn_u32 v66, v86, v7
    ds_add_rtn_u32 v67, v87, v7
    s_mov_b64 exec, -1
    v_mul_u32_u24 v2, 42909, v48
    v_lshrrev_b32 v2, 24, v2
    v_mad_i32_i24 v48, v2, s7, v48
    v_and_b32 v80, 62, v2
    v_and_b32 v2, 1, v2
    v_lshlrev_b32 v80, 1, v80
    v_lshl_or_b32 v80, v2, 7, v80
    v_add_u32 v88, s6, v80
    v_mul_u32_u24 v2, 42909, v49
    v_lshrrev_b32 v2, 24, v2
    v_mad_i32_i24 v49, v2, s7, v49
    v_and_b32 v81, 62, v2
    v_and_b32 v2, 1, v2
    v_lshlrev_b32 v81, 1, v81
    v_lshl_or_b32 v81, v2, 7, v81
    v_add_u32 v89, s6, v81
    v_mul_u32_u24 v2, 42909, v50
    v_lshrrev_b32 v2, 24, v2
    v_mad_i32_i24 v50, v2, s7, v50
    v_and_b32 v82, 62, v2
    v_and_b32 v2, 1, v2
    v_lshlrev_b32 v82, 1, v82
    v_lshl_or_b32 v82, v2, 7, v82
    v_add_u32 v90, s6, v82
    v_mul_u32_u24 v2, 42909, v51
    v_lshrrev_b32 v2, 24, v2
    v_mad_i32_i24 v51, v2, s7, v51
    v_and_b32 v83, 62, v2
    v_and_b32 v2, 1, v2
    v_lshlrev_b32 v83, 1, v83
    v_lshl_or_b32 v83, v2, 7, v83
    v_add_u32 v91, s6, v83
    s_mov_b64 exec, s[80:81]
    ds_add_rtn_u32 v68, v88, v7
    ds_add_rtn_u32 v69, v89, v7
    ds_add_rtn_u32 v70, v90, v7
    ds_add_rtn_u32 v71, v91, v7
    s_mov_b64 exec, -1
    s_waitcnt lgkmcnt(0)
    s_mov_b64 exec, 1
    ds_add_u32 v9, v7 offset:4
    s_mov_b64 exec, -1
    v_lshl_or_b32 v84, v60, 16, v52
    v_and_b32 v2, 1, v44
    v_lshl_or_b32 v84, v2, 15, v84
    v_lshrrev_b32 v92, 1, v44
    v_and_or_b32 v85, v60, s72, v53
    v_and_b32 v2, 1, v45
    v_lshl_or_b32 v85, v2, 15, v85
    v_lshrrev_b32 v93, 1, v45
    v_lshl_or_b32 v86, v61, 16, v54
    v_and_b32 v2, 1, v46
    v_lshl_or_b32 v86, v2, 15, v86
    v_lshrrev_b32 v94, 1, v46
    v_and_or_b32 v87, v61, s72, v55
    v_and_b32 v2, 1, v47
    v_lshl_or_b32 v87, v2, 15, v87
    v_lshrrev_b32 v95, 1, v47
    v_lshl_or_b32 v88, v62, 16, v56
    v_and_b32 v2, 1, v48
    v_lshl_or_b32 v88, v2, 15, v88
    v_lshrrev_b32 v96, 1, v48
    v_and_or_b32 v89, v62, s72, v57
    v_and_b32 v2, 1, v49
    v_lshl_or_b32 v89, v2, 15, v89
    v_lshrrev_b32 v97, 1, v49
    v_lshl_or_b32 v90, v63, 16, v58
    v_and_b32 v2, 1, v50
    v_lshl_or_b32 v90, v2, 15, v90
    v_lshrrev_b32 v98, 1, v50
    v_and_or_b32 v91, v63, s72, v59
    v_and_b32 v2, 1, v51
    v_lshl_or_b32 v91, v2, 15, v91
    v_lshrrev_b32 v99, 1, v51
    v_lshlrev_b32 v2, 2, v6
    v_add_u32 v3, 161760, v2
    s_mov_b32 s1, 0x400000
SP_1:
    ds_read_b32 v4, v9 offset:4
    s_waitcnt lgkmcnt(0)
    v_readfirstlane_b32 s6, v4
    s_cmp_ge_u32 s6, 4
    s_cbranch_scc1 SPD_2
    s_sleep 1
    s_sub_u32 s1, s1, 1
    s_cbranch_scc0 SP_1
SPD_2:
    ds_read_b32 v100, v3
    s_waitcnt lgkmcnt(0)
    v_add_u32 v103, 1, v100
    v_and_b32 v103, -2, v103
    v_mov_b32 v102, v103
    s_nop 1
    v_add_u32_dpp v102, v102, v102 row_shr:1 row_mask:0xf bank_mask:0xf
    s_nop 1
    v_add_u32_dpp v102, v102, v102 row_shr:2 row_mask:0xf bank_mask:0xf
    s_nop 1
    v_add_u32_dpp v102, v102, v102 row_shr:4 row_mask:0xf bank_mask:0xf
    s_nop 1
    v_add_u32_dpp v102, v102, v102 row_shr:8 row_mask:0xf bank_mask:0xf
    s_nop 1
    v_add_u32_dpp v102, v102, v102 row_bcast:15 row_mask:0xa bank_mask:0xf
    s_nop 1
    v_add_u32_dpp v102, v102, v102 row_bcast:31 row_mask:0xc bank_mask:0xf
    v_sub_u32 v102, v102, v103
    ds_bpermute_b32 v44, v76, v102
    ds_bpermute_b32 v45, v77, v102
    ds_bpermute_b32 v46, v78, v102
    ds_bpermute_b32 v47, v79, v102
    ds_bpermute_b32 v48, v80, v102
    ds_bpermute_b32 v49, v81, v102
    ds_bpermute_b32 v50, v82, v102
    ds_bpermute_b32 v51, v83, v102
    v_lshl_or_b32 v100, v100, 16, v102
    s_waitcnt lgkmcnt(7)
    v_add_u32 v44, v44, v64
    v_lshlrev_b32 v64, 2, v44
    s_waitcnt lgkmcnt(6)
    v_add_u32 v45, v45, v65
    v_lshlrev_b32 v65, 2, v45
    s_waitcnt lgkmcnt(5)
    v_add_u32 v46, v46, v66
    v_lshlrev_b32 v66, 2, v46
    s_waitcnt lgkmcnt(4)
    v_add_u32 v47, v47, v67
    v_lshlrev_b32 v67, 2, v47
    s_waitcnt lgkmcnt(3)
    v_add_u32 v48, v48, v68
    v_lshlrev_b32 v68, 2, v48
    s_waitcnt lgkmcnt(2)
    v_add_u32 v49, v49, v69
    v_lshlrev_b32 v69, 2, v49
    s_waitcnt lgkmcnt(1)
    v_add_u32 v50, v50, v70
    v_lshlrev_b32 v70, 2, v50
    s_waitcnt lgkmcnt(0)
    v_add_u32 v51, v51, v71
    v_lshlrev_b32 v71, 2, v51
    s_mov_b64 exec, s[10:11]
    ds_write_b32 v64, v84 offset:0
    ds_write_b8 v44, v92 offset:6528
    ds_write_b32 v65, v85 offset:0
    ds_write_b8 v45, v93 offset:6528
    ds_write_b32 v66, v86 offset:0
    ds_write_b8 v46, v94 offset:6528
    ds_write_b32 v67, v87 offset:0
    ds_write_b8 v47, v95 offset:6528
    s_mov_b64 exec, s[80:81]
    ds_write_b32 v68, v88 offset:0
    ds_write_b8 v48, v96 offset:6528
    ds_write_b32 v69, v89 offset:0
    ds_write_b8 v49, v97 offset:6528
    ds_write_b32 v70, v90 offset:0
    ds_write_b8 v50, v98 offset:6528
    ds_write_b32 v71, v91 offset:0
    ds_write_b8 v51, v99 offset:6528
    s_mov_b64 exec, -1
    s_waitcnt lgkmcnt(0)
    s_mov_b64 exec, 1
    ds_add_u32 v9, v7 offset:8
    s_mov_b64 exec, -1
    s_waitcnt vmcnt(1)
    s_mov_b64 exec, 1
    ds_add_u32 v9, v7 offset:16
    s_mov_b64 exec, -1
    v_lshlrev_b32 v3, 4, v0
    s_mov_b32 s1, 0x400000
SP_3:
    ds_read_b32 v5, v9 offset:8
    s_waitcnt lgkmcnt(0)
    v_readfirstlane_b32 s6, v5
    s_cmp_ge_u32 s6, 4
    s_cbranch_scc1 SPD_4
    s_sleep 1
    s_sub_u32 s1, s1, 1
    s_cbranch_scc0 SP_3
SPD_4:
    ds_read_b128 v[44:47], v3 offset:0
    ds_read_b128 v[48:51], v3 offset:4096
    s_lshl_b32 s6, s2, 13
    s_add_u32 s7, s6, 4096
    s_waitcnt lgkmcnt(1)
    buffer_store_dwordx4 v[44:47], v3, s[52:55], s6 offen sc1
    s_waitcnt lgkmcnt(0)
    buffer_store_dwordx4 v[48:51], v3, s[52:55], s7 offen sc1
    s_cmp_lg_u32 s3, 0
    s_cbranch_scc1 K_NOLAST
    s_mov_b32 m0, s101
    s_brev_b32 s7, 1
    v_xor_b32 v108, 0, v23
    v_add_u32 v109, 0, v21
    v_add_u32 v108, v108, v109
    v_subrev_u32 v109, 0, v22
    v_and_or_b32 v108, v109, s7, v108
    buffer_load_dwordx4 v108, s[40:43], 0 offen lds
    s_add_u32 m0, m0, 1024
    v_xor_b32 v108, 64, v23
    v_add_u32 v109, 2048, v21
    v_add_u32 v108, v108, v109
    v_subrev_u32 v109, 8, v22
    v_and_or_b32 v108, v109, s7, v108
    buffer_load_dwordx4 v108, s[40:43], 0 offen lds
    s_add_u32 m0, m0, 1024
    v_xor_b32 v108, 0, v23
    v_add_u32 v109, 4096, v21
    v_add_u32 v108, v108, v109
    v_subrev_u32 v109, 16, v22
    v_and_or_b32 v108, v109, s7, v108
    buffer_load_dwordx4 v108, s[40:43], 0 offen lds
    s_add_u32 m0, m0, 1024
    v_xor_b32 v108, 64, v23
    v_add_u32 v109, 6144, v21
    v_add_u32 v108, v108, v109
    v_subrev_u32 v109, 24, v22
    v_and_or_b32 v108, v109, s7, v108
    buffer_load_dwordx4 v108, s[40:43], 0 offen lds
K_NOLAST:
    v_mov_b32 v4, 0
    s_mov_b32 s1, 0x100000
K_GOL:
    buffer_load_dword v101, v4, s[68:71], 0 offen sc1
    s_waitcnt vmcnt(0)
    v_readfirstlane_b32 s32, v101
    s_cmp_lg_u32 s32, 0
    s_cbranch_scc1 K_GOD
    s_sub_u32 s1, s1, 1
    s_cbranch_scc0 K_GOL
K_GOD:
    ds_write_b32 v9, v101 offset:36
    s_mov_b64 exec, 1
    ds_add_rtn_u32 v5, v9, v7 offset:12
    s_mov_b64 exec, -1
    v_lshlrev_b32 v3, 3, v6
    s_lshl_b32 s7, s2, 9
    s_waitcnt lgkmcnt(0)
    v_readfirstlane_b32 s6, v5
    s_cmp_lg_u32 s6, 3
    s_cbranch_scc1 K_NOFLAGA
    buffer_store_dwordx2 v[100:101], v3, s[56:59], s7 offen sc1
K_NOFLAGA:
    s_cmp_eq_u32 s3, 0
    s_cbranch_scc1 K_GEMM
    s_cmp_lg_u32 s3, 3
    s_cbranch_scc1 K_RECS
    s_mov_b32 s1, 0x400000
SP_5:
    ds_read_b32 v3, v9 offset:20
    s_waitcnt lgkmcnt(0)
    v_readfirstlane_b32 s6, v3
    s_cmp_ge_u32 s6, 12
    s_cbranch_scc1 SPD_6
    s_sleep 1
    s_sub_u32 s1, s1, 1
    s_cbranch_scc0 SP_5
SPD_6:
    s_lshr_b32 s6, s5, 1
    s_and_b32 s7, s5, 1
    s_lshl_b32 s7, s7, 5
    s_or_b32 s6, s6, s7
    s_lshl_b32 s6, s6, 3
    v_lshlrev_b32 v3, 9, v6
    v_add_u32 v3, s6, v3
    s_mov_b64 s[16:17], -1
    s_mov_b64 s[18:19], -1
    s_mov_b64 s[20:21], -1
    s_mov_b64 s[22:23], -1
    s_mov_b32 s1, 0x100000
TP_7:
    s_mov_b64 exec, s[16:17]
    s_cbranch_execz PA_10
    s_mov_b32 s6, 0
    buffer_load_dwordx2 v[44:45], v3, s[56:59], s6 offen sc1
PA_10:
    s_mov_b64 exec, s[18:19]
    s_cbranch_execz PA_11
    s_mov_b32 s6, 32768
    buffer_load_dwordx2 v[46:47], v3, s[56:59], s6 offen sc1
PA_11:
    s_mov_b64 exec, s[20:21]
    s_cbranch_execz PA_12
    s_mov_b32 s6, 65536
    buffer_load_dwordx2 v[48:49], v3, s[56:59], s6 offen sc1
PA_12:
    s_mov_b64 exec, s[22:23]
    s_cbranch_execz PA_13
    s_mov_b32 s6, 98304
    buffer_load_dwordx2 v[50:51], v3, s[56:59], s6 offen sc1
PA_13:
    s_mov_b64 exec, -1
TPC_8:
    s_waitcnt vmcnt(0)
    v_cmp_ne_u32 s[16:17], s32, v45
    v_cmp_ne_u32 s[18:19], s32, v47
    v_cmp_ne_u32 s[20:21], s32, v49
    v_cmp_ne_u32 s[22:23], s32, v51
    s_or_b64 s[8:9], s[16:17], s[18:19]
    s_or_b64 vcc, s[20:21], s[22:23]
    s_or_b64 vcc, vcc, s[8:9]
    s_cbranch_vccz TPD_9
    s_sleep 2
    s_sub_u32 s1, s1, 1
    s_cbranch_scc0 TP_7
TPD_9:
    v_add_u32 v3, 162096, v2
    ds_write_b32 v3, v44 offset:0
    ds_write_b32 v3, v46 offset:256
    ds_write_b32 v3, v48 offset:512
    ds_write_b32 v3, v50 offset:768
    s_waitcnt lgkmcnt(0)
    s_mov_b64 exec, 1
    ds_add_u32 v9, v7 offset:28
    s_mov_b64 exec, -1
    s_branch K_RECS
K_GEMM:
    v_and_b32 v2, 31, v6
    v_lshrrev_b32 v4, 5, v6
    v_lshl_add_u32 v3, v2, 7, s101
    v_bfe_u32 v5, v6, 1, 3
    v_xor_b32 v5, v5, v4
    v_lshlrev_b32 v5, 4, v5
    v_xor_b32 v24, 0, v5
    v_add_u32 v24, v24, v3
    v_xor_b32 v25, 32, v5
    v_add_u32 v25, v25, v3
    v_xor_b32 v26, 64, v5
    v_add_u32 v26, v26, v3
    v_xor_b32 v27, 96, v5
    v_add_u32 v27, v27, v3
    v_mul_u32_u24 v18, 144, v2
    v_lshl_add_u32 v18, v4, 4, v18
    v_add_u32 v18, s101, v18
    v_lshlrev_b32 v19, 3, v4
    v_bfe_u32 v2, v6, 2, 2
    v_add_u32 v19, v19, v2
    v_lshlrev_b32 v19, 6, v19
    v_bfe_u32 v2, v6, 4, 1
    v_lshl_add_u32 v19, v2, 5, v19
    v_and_b32 v2, 1, v6
    v_lshl_add_u32 v19, v2, 4, v19
    v_and_b32 v2, 2, v6
    v_lshl_add_u32 v19, v2, 2, v19
    v_add_u32 v19, 125504, v19
    v_mov_b32 v20, 0x7f7f7fff
    s_waitcnt vmcnt(0)
    ds_read_b128 v[44:47], v24
    ds_read_b128 v[48:51], v25
    ds_read_b128 v[52:55], v26
    ds_read_b128 v[56:59], v27
    s_waitcnt lgkmcnt(0)
    s_mov_b32 m0, s101
    s_brev_b32 s7, 1
    v_xor_b32 v108, 0, v23
    v_add_u32 v109, 128, v21
    v_add_u32 v108, v108, v109
    v_subrev_u32 v109, 0, v22
    v_and_or_b32 v108, v109, s7, v108
    buffer_load_dwordx4 v108, s[40:43], 0 offen lds
    s_add_u32 m0, m0, 1024
    v_xor_b32 v108, 64, v23
    v_add_u32 v109, 2176, v21
    v_add_u32 v108, v108, v109
    v_subrev_u32 v109, 8, v22
    v_and_or_b32 v108, v109, s7, v108
    buffer_load_dwordx4 v108, s[40:43], 0 offen lds
    s_add_u32 m0, m0, 1024
    v_xor_b32 v108, 0, v23
    v_add_u32 v109, 4224, v21
    v_add_u32 v108, v108, v109
    v_subrev_u32 v109, 16, v22
    v_and_or_b32 v108, v109, s7, v108
    buffer_load_dwordx4 v108, s[40:43], 0 offen lds
    s_add_u32 m0, m0, 1024
    v_xor_b32 v108, 64, v23
    v_add_u32 v109, 6272, v21
    v_add_u32 v108, v108, v109
    v_subrev_u32 v109, 24, v22
    v_and_or_b32 v108, v109, s7, v108
    buffer_load_dwordx4 v108, s[40:43], 0 offen lds
    s_mov_b32 s1, 0x400000
SP_14:
    ds_read_b32 v2, v9 offset:16
    s_waitcnt lgkmcnt(0)
    v_readfirstlane_b32 s6, v2
    s_cmp_ge_u32 s6, 4
    s_cbranch_scc1 SPD_15
    s_sleep 1
    s_sub_u32 s1, s1, 1
    s_cbranch_scc0 SP_14
SPD_15:
    ds_read_b64_tr_b16 v[76:77], v19 offset:0
    ds_read_b64_tr_b16 v[78:79], v19 offset:256
    ds_read_b64_tr_b16 v[80:81], v19 offset:1024
    ds_read_b64_tr_b16 v[82:83], v19 offset:1280
    ds_read_b64_tr_b16 v[84:85], v19 offset:2048
    ds_read_b64_tr_b16 v[86:87], v19 offset:2304
    ds_read_b64_tr_b16 v[88:89], v19 offset:3072
    ds_read_b64_tr_b16 v[90:91], v19 offset:3328
    ds_read_b64_tr_b16 v[92:93], v19 offset:8192
    ds_read_b64_tr_b16 v[94:95], v19 offset:8448
    ds_read_b64_tr_b16 v[96:97], v19 offset:9216
    ds_read_b64_tr_b16 v[98:99], v19 offset:9472
    ds_read_b64_tr_b16 v[100:101], v19 offset:10240
    ds_read_b64_tr_b16 v[102:103], v19 offset:10496
    ds_read_b64_tr_b16 v[104:105], v19 offset:11264
    ds_read_b64_tr_b16 v[106:107], v19 offset:11520
    s_waitcnt lgkmcnt(0)
    v_mfma_f32_32x32x16_bf16 v[108:123], v[76:79], v[44:47], 0
    v_mfma_f32_32x32x16_bf16 v[28:43], v[92:95], v[44:47], 0
    v_mfma_f32_32x32x16_bf16 v[108:123], v[80:83], v[48:51], v[108:123]
    v_mfma_f32_32x32x16_bf16 v[28:43], v[96:99], v[48:51], v[28:43]
    v_mfma_f32_32x32x16_bf16 v[108:123], v[84:87], v[52:55], v[108:123]
    v_mfma_f32_32x32x16_bf16 v[28:43], v[100:103], v[52:55], v[28:43]
    v_mfma_f32_32x32x16_bf16 v[108:123], v[88:91], v[56:59], v[108:123]
    v_mfma_f32_32x32x16_bf16 v[28:43], v[104:107], v[56:59], v[28:43]
    ds_read_b64_tr_b16 v[76:77], v19 offset:4096
    ds_read_b64_tr_b16 v[78:79], v19 offset:4352
    ds_read_b64_tr_b16 v[80:81], v19 offset:5120
    ds_read_b64_tr_b16 v[82:83], v19 offset:5376
    ds_read_b64_tr_b16 v[84:85], v19 offset:6144
    ds_read_b64_tr_b16 v[86:87], v19 offset:6400
    ds_read_b64_tr_b16 v[88:89], v19 offset:7168
    ds_read_b64_tr_b16 v[90:91], v19 offset:7424
    ds_read_b64_tr_b16 v[92:93], v19 offset:12288
    ds_read_b64_tr_b16 v[94:95], v19 offset:12544
    ds_read_b64_tr_b16 v[96:97], v19 offset:13312
    ds_read_b64_tr_b16 v[98:99], v19 offset:13568
    ds_read_b64_tr_b16 v[100:101], v19 offset:14336
    ds_read_b64_tr_b16 v[102:103], v19 offset:14592
    ds_read_b64_tr_b16 v[104:105], v19 offset:15360
    ds_read_b64_tr_b16 v[106:107], v19 offset:15616
    s_waitcnt vmcnt(0)
    s_mov_b64 exec, 1
    ds_add_u32 v9, v7 offset:20
    s_mov_b64 exec, -1
    s_setprio 3
    ds_read_b128 v[60:63], v24
    ds_read_b128 v[64:67], v25
    ds_read_b128 v[68:71], v26
    ds_read_b128 v[72:75], v27
    s_waitcnt lgkmcnt(0)
    v_mfma_f32_32x32x16_bf16 v[108:123], v[76:79], v[60:63], v[108:123]
    v_mfma_f32_32x32x16_bf16 v[28:43], v[92:95], v[60:63], v[28:43]
    v_mfma_f32_32x32x16_bf16 v[108:123], v[80:83], v[64:67], v[108:123]
    v_mfma_f32_32x32x16_bf16 v[28:43], v[96:99], v[64:67], v[28:43]
    v_mfma_f32_32x32x16_bf16 v[108:123], v[84:87], v[68:71], v[108:123]
    v_mfma_f32_32x32x16_bf16 v[28:43], v[100:103], v[68:71], v[28:43]
    v_mfma_f32_32x32x16_bf16 v[108:123], v[88:91], v[72:75], v[108:123]
    v_mfma_f32_32x32x16_bf16 v[28:43], v[104:107], v[72:75], v[28:43]
    ds_read_b64_tr_b16 v[76:77], v19 offset:16384
    ds_read_b64_tr_b16 v[78:79], v19 offset:16640
    ds_read_b64_tr_b16 v[80:81], v19 offset:17408
    ds_read_b64_tr_b16 v[82:83], v19 offset:17664
    ds_read_b64_tr_b16 v[84:85], v19 offset:18432
    ds_read_b64_tr_b16 v[86:87], v19 offset:18688
    ds_read_b64_tr_b16 v[88:89], v19 offset:19456
    ds_read_b64_tr_b16 v[90:91], v19 offset:19712
    ds_read_b64_tr_b16 v[92:93], v19 offset:20480
    ds_read_b64_tr_b16 v[94:95], v19 offset:20736
    ds_read_b64_tr_b16 v[96:97], v19 offset:21504
    ds_read_b64_tr_b16 v[98:99], v19 offset:21760
    ds_read_b64_tr_b16 v[100:101], v19 offset:22528
    ds_read_b64_tr_b16 v[102:103], v19 offset:22784
    ds_read_b64_tr_b16 v[104:105], v19 offset:23552
    ds_read_b64_tr_b16 v[106:107], v19 offset:23808
    v_mul_f32 v108, s77, v108
    v_mul_f32 v109, s77, v109
    v_mul_f32 v110, s77, v110
    v_mul_f32 v111, s77, v111
    v_mul_f32 v112, s77, v112
    v_mul_f32 v113, s77, v113
    v_mul_f32 v114, s77, v114
    v_mul_f32 v115, s77, v115
    v_mul_f32 v116, s77, v116
    v_mul_f32 v117, s77, v117
    v_mul_f32 v118, s77, v118
    v_mul_f32 v119, s77, v119
    v_mul_f32 v120, s77, v120
    v_mul_f32 v121, s77, v121
    v_mul_f32 v122, s77, v122
    v_mul_f32 v123, s77, v123
    v_max3_f32 v2, |v108|, |v109|, |v110|
    v_max3_f32 v3, |v111|, |v112|, |v113|
    v_max3_f32 v2, v2, |v114|, |v115|
    v_max3_f32 v3, v3, |v116|, |v117|
    v_max3_f32 v2, v2, |v118|, |v119|
    v_max3_f32 v3, v3, |v120|, |v121|
    v_max3_f32 v2, v2, |v122|, |v123|
    v_max_f32 v2, v2, v3
    v_cmp_lt_f32 vcc, 0x41980000, v2
    s_cbranch_vccz RC_16
    ds_write_b32 v9, v7 offset:48
    v_cmp_lt_f32 vcc, 0x42f00000, v2
    s_waitcnt lgkmcnt(0)
    s_cbranch_vccz RC_16
    s_lshl_b32 s6, 1, s100
    v_mov_b32 v2, s6
    ds_or_b32 v9, v2 offset:52
    v_bfrev_b32 v2, 1
    v_or_b32 v2, v2, v20
    v_med3_f32 v108, v108, v2, v20
    v_med3_f32 v109, v109, v2, v20
    v_med3_f32 v110, v110, v2, v20
    v_med3_f32 v111, v111, v2, v20
    v_med3_f32 v112, v112, v2, v20
    v_med3_f32 v113, v113, v2, v20
    v_med3_f32 v114, v114, v2, v20
    v_med3_f32 v115, v115, v2, v20
    v_med3_f32 v116, v116, v2, v20
    v_med3_f32 v117, v117, v2, v20
    v_med3_f32 v118, v118, v2, v20
    v_med3_f32 v119, v119, v2, v20
    v_med3_f32 v120, v120, v2, v20
    v_med3_f32 v121, v121, v2, v20
    v_med3_f32 v122, v122, v2, v20
    v_med3_f32 v123, v123, v2, v20
    s_waitcnt lgkmcnt(0)
    s_branch K_RAWB
RC_16:
    v_exp_f32 v108, v108
    v_exp_f32 v109, v109
    v_exp_f32 v110, v110
    v_exp_f32 v111, v111
    v_exp_f32 v112, v112
    v_exp_f32 v113, v113
    v_exp_f32 v114, v114
    v_exp_f32 v115, v115
    v_exp_f32 v116, v116
    v_exp_f32 v117, v117
    v_exp_f32 v118, v118
    v_exp_f32 v119, v119
    v_exp_f32 v120, v120
    v_exp_f32 v121, v121
    v_exp_f32 v122, v122
    v_exp_f32 v123, v123
K_RAWB:
    v_add_u32 v108, 0x8000, v108
    v_add_u32 v112, 0x8000, v112
    v_add_u32 v116, 0x8000, v116
    v_add_u32 v120, 0x8000, v120
    v_perm_b32 v108, v109, v108, s76
    v_perm_b32 v109, v111, v110, s76
    v_perm_b32 v110, v113, v112, s76
    v_perm_b32 v111, v115, v114, s76
    v_perm_b32 v112, v117, v116, s76
    v_perm_b32 v113, v119, v118, s76
    v_perm_b32 v114, v121, v120, s76
    v_perm_b32 v115, v123, v122, s76
    ds_write_b128 v18, v[108:111]
    ds_write_b128 v18, v[112:115] offset:32
    v_max3_f32 v2, |v28|, |v29|, |v30|
    v_max3_f32 v3, |v31|, |v32|, |v33|
    v_max3_f32 v2, v2, |v34|, |v35|
    v_max3_f32 v3, v3, |v36|, |v37|
    v_max3_f32 v2, v2, |v38|, |v39|
    v_max3_f32 v3, v3, |v40|, |v41|
    v_max3_f32 v2, v2, |v42|, |v43|
    v_max_f32 v2, v2, v3
    v_cmp_lt_f32 vcc, 0x5d800000, v2
    s_cbranch_vccz RC_17
    ds_write_b32 v9, v7 offset:48
    v_bfrev_b32 v2, 1
    v_or_b32 v2, v2, v20
    v_med3_f32 v28, v28, v2, v20
    v_med3_f32 v29, v29, v2, v20
    v_med3_f32 v30, v30, v2, v20
    v_med3_f32 v31, v31, v2, v20
    v_med3_f32 v32, v32, v2, v20
    v_med3_f32 v33, v33, v2, v20
    v_med3_f32 v34, v34, v2, v20
    v_med3_f32 v35, v35, v2, v20
    v_med3_f32 v36, v36, v2, v20
    v_med3_f32 v37, v37, v2, v20
    v_med3_f32 v38, v38, v2, v20
    v_med3_f32 v39, v39, v2, v20
    v_med3_f32 v40, v40, v2, v20
    v_med3_f32 v41, v41, v2, v20
    v_med3_f32 v42, v42, v2, v20
    v_med3_f32 v43, v43, v2, v20
    s_waitcnt lgkmcnt(0)
RC_17:
    v_add_u32 v28, 0x8000, v28
    v_add_u32 v32, 0x8000, v32
    v_add_u32 v36, 0x8000, v36
    v_add_u32 v40, 0x8000, v40
    v_perm_b32 v28, v29, v28, s76
    v_perm_b32 v29, v31, v30, s76
    v_perm_b32 v30, v33, v32, s76
    v_perm_b32 v31, v35, v34, s76
    v_perm_b32 v32, v37, v36, s76
    v_perm_b32 v33, v39, v38, s76
    v_perm_b32 v34, v41, v40, s76
    v_perm_b32 v35, v43, v42, s76
    ds_write_b128 v18, v[28:31] offset:64
    ds_write_b128 v18, v[32:35] offset:96
    v_lshrrev_b32 v2, 3, v6
    v_and_b32 v3, 7, v6
    v_lshlrev_b32 v3, 4, v3
    v_mul_u32_u24 v4, 144, v2
    v_add3_u32 v4, v4, v3, s101
    v_lshrrev_b32 v2, 1, v21
    v_add_u32 v2, v2, v3
    s_brev_b32 s7, 1
    s_waitcnt lgkmcnt(0)
    ds_read_b128 v[28:31], v4 offset:0
    ds_read_b128 v[32:35], v4 offset:1152
    ds_read_b128 v[36:39], v4 offset:2304
    ds_read_b128 v[40:43], v4 offset:3456
    v_subrev_u32 v5, 0, v22
    v_and_or_b32 v3, v5, s7, v2
    s_waitcnt lgkmcnt(3)
    buffer_store_dwordx4 v[28:31], v3, s[48:51], 0 offen offset:0 sc1
    v_subrev_u32 v5, 8, v22
    v_and_or_b32 v3, v5, s7, v2
    s_waitcnt lgkmcnt(2)
    buffer_store_dwordx4 v[32:35], v3, s[48:51], 0 offen offset:1024 sc1
    v_subrev_u32 v5, 16, v22
    v_and_or_b32 v3, v5, s7, v2
    s_waitcnt lgkmcnt(1)
    buffer_store_dwordx4 v[36:39], v3, s[48:51], 0 offen offset:2048 sc1
    v_subrev_u32 v5, 24, v22
    v_and_or_b32 v3, v5, s7, v2
    s_waitcnt lgkmcnt(0)
    buffer_store_dwordx4 v[40:43], v3, s[48:51], 0 offen offset:3072 sc1
    s_setprio 0
    v_mfma_f32_32x32x16_bf16 v[108:123], v[76:79], v[44:47], 0
    v_mfma_f32_32x32x16_bf16 v[108:123], v[80:83], v[48:51], v[108:123]
    v_mfma_f32_32x32x16_bf16 v[108:123], v[84:87], v[52:55], v[108:123]
    v_mfma_f32_32x32x16_bf16 v[108:123], v[88:91], v[56:59], v[108:123]
    v_mfma_f32_32x32x16_bf16 v[108:123], v[92:95], v[60:63], v[108:123]
    v_mfma_f32_32x32x16_bf16 v[108:123], v[96:99], v[64:67], v[108:123]
    v_mfma_f32_32x32x16_bf16 v[108:123], v[100:103], v[68:71], v[108:123]
    v_mfma_f32_32x32x16_bf16 v[108:123], v[104:107], v[72:75], v[108:123]
    ds_read_b64_tr_b16 v[76:77], v19 offset:24576
    ds_read_b64_tr_b16 v[78:79], v19 offset:24832
    ds_read_b64_tr_b16 v[80:81], v19 offset:25600
    ds_read_b64_tr_b16 v[82:83], v19 offset:25856
    ds_read_b64_tr_b16 v[84:85], v19 offset:26624
    ds_read_b64_tr_b16 v[86:87], v19 offset:26880
    ds_read_b64_tr_b16 v[88:89], v19 offset:27648
    ds_read_b64_tr_b16 v[90:91], v19 offset:27904
    ds_read_b64_tr_b16 v[92:93], v19 offset:28672
    ds_read_b64_tr_b16 v[94:95], v19 offset:28928
    ds_read_b64_tr_b16 v[96:97], v19 offset:29696
    ds_read_b64_tr_b16 v[98:99], v19 offset:29952
    ds_read_b64_tr_b16 v[100:101], v19 offset:30720
    ds_read_b64_tr_b16 v[102:103], v19 offset:30976
    ds_read_b64_tr_b16 v[104:105], v19 offset:31744
    ds_read_b64_tr_b16 v[106:107], v19 offset:32000
    v_mul_f32 v108, s77, v108
    v_mul_f32 v109, s77, v109
    v_mul_f32 v110, s77, v110
    v_mul_f32 v111, s77, v111
    v_mul_f32 v112, s77, v112
    v_mul_f32 v113, s77, v113
    v_mul_f32 v114, s77, v114
    v_mul_f32 v115, s77, v115
    v_mul_f32 v116, s77, v116
    v_mul_f32 v117, s77, v117
    v_mul_f32 v118, s77, v118
    v_mul_f32 v119, s77, v119
    v_mul_f32 v120, s77, v120
    v_mul_f32 v121, s77, v121
    v_mul_f32 v122, s77, v122
    v_mul_f32 v123, s77, v123
    v_max3_f32 v2, |v108|, |v109|, |v110|
    v_max3_f32 v3, |v111|, |v112|, |v113|
    v_max3_f32 v2, v2, |v114|, |v115|
    v_max3_f32 v3, v3, |v116|, |v117|
    v_max3_f32 v2, v2, |v118|, |v119|
    v_max3_f32 v3, v3, |v120|, |v121|
    v_max3_f32 v2, v2, |v122|, |v123|
    v_max_f32 v2, v2, v3
    v_cmp_lt_f32 vcc, 0x41980000, v2
    s_cbranch_vccz RC_18
    ds_write_b32 v9, v7 offset:44
    v_bfrev_b32 v2, 1
    v_or_b32 v2, v2, v20
    v_med3_f32 v108, v108, v2, v20
    v_med3_f32 v109, v109, v2, v20
    v_med3_f32 v110, v110, v2, v20
    v_med3_f32 v111, v111, v2, v20
    v_med3_f32 v112, v112, v2, v20
    v_med3_f32 v113, v113, v2, v20
    v_med3_f32 v114, v114, v2, v20
    v_med3_f32 v115, v115, v2, v20
    v_med3_f32 v116, v116, v2, v20
    v_med3_f32 v117, v117, v2, v20
    v_med3_f32 v118, v118, v2, v20
    v_med3_f32 v119, v119, v2, v20
    v_med3_f32 v120, v120, v2, v20
    v_med3_f32 v121, v121, v2, v20
    v_med3_f32 v122, v122, v2, v20
    v_med3_f32 v123, v123, v2, v20
    s_waitcnt lgkmcnt(0)
RC_18:
    v_cvt_pk_bf16_f32 v108, v108, v109
    v_cvt_pk_bf16_f32 v109, v110, v111
    v_cvt_pk_bf16_f32 v110, v112, v113
    v_cvt_pk_bf16_f32 v111, v114, v115
    v_cvt_pk_bf16_f32 v112, v116, v117
    v_cvt_pk_bf16_f32 v113, v118, v119
    v_cvt_pk_bf16_f32 v114, v120, v121
    v_cvt_pk_bf16_f32 v115, v122, v123
    ds_write_b128 v18, v[108:111] offset:0
    ds_write_b128 v18, v[112:115] offset:32
    s_waitcnt lgkmcnt(2)
    v_mfma_f32_32x32x16_bf16 v[28:43], v[76:79], v[44:47], 0
    v_mfma_f32_32x32x16_bf16 v[28:43], v[80:83], v[48:51], v[28:43]
    v_mfma_f32_32x32x16_bf16 v[28:43], v[84:87], v[52:55], v[28:43]
    v_mfma_f32_32x32x16_bf16 v[28:43], v[88:91], v[56:59], v[28:43]
    v_mfma_f32_32x32x16_bf16 v[28:43], v[92:95], v[60:63], v[28:43]
    v_mfma_f32_32x32x16_bf16 v[28:43], v[96:99], v[64:67], v[28:43]
    v_mfma_f32_32x32x16_bf16 v[28:43], v[100:103], v[68:71], v[28:43]
    v_mfma_f32_32x32x16_bf16 v[28:43], v[104:107], v[72:75], v[28:43]
    s_nop 11
    v_cvt_pk_bf16_f32 v28, v28, v29
    v_cvt_pk_bf16_f32 v29, v30, v31
    v_cvt_pk_bf16_f32 v30, v32, v33
    v_cvt_pk_bf16_f32 v31, v34, v35
    v_cvt_pk_bf16_f32 v32, v36, v37
    v_cvt_pk_bf16_f32 v33, v38, v39
    v_cvt_pk_bf16_f32 v34, v40, v41
    v_cvt_pk_bf16_f32 v35, v42, v43
    ds_write_b128 v18, v[28:31] offset:64
    ds_write_b128 v18, v[32:35] offset:96
    s_mov_b64 exec, 1
    ds_add_u32 v9, v7 offset:56
    s_mov_b64 exec, -1
    s_cmp_lg_u32 s4, 0
    s_cbranch_scc1 XC_19
    v_mov_b64 v[36:37], v[44:45]
    v_mov_b64 v[38:39], v[46:47]
    v_mov_b64 v[40:41], v[48:49]
    v_mov_b64 v[42:43], v[50:51]
XC_19:
    s_cmp_lg_u32 s4, 1
    s_cbranch_scc1 XC_20
    v_mov_b64 v[36:37], v[52:53]
    v_mov_b64 v[38:39], v[54:55]
    v_mov_b64 v[40:41], v[56:57]
    v_mov_b64 v[42:43], v[58:59]
XC_20:
    s_cmp_lg_u32 s4, 2
    s_cbranch_scc1 XC_21
    v_mov_b64 v[36:37], v[60:61]
    v_mov_b64 v[38:39], v[62:63]
    v_mov_b64 v[40:41], v[64:65]
    v_mov_b64 v[42:43], v[66:67]
XC_21:
    s_cmp_lg_u32 s4, 3
    s_cbranch_scc1 XC_22
    v_mov_b64 v[36:37], v[68:69]
    v_mov_b64 v[38:39], v[70:71]
    v_mov_b64 v[40:41], v[72:73]
    v_mov_b64 v[42:43], v[74:75]
XC_22:
    s_mov_b32 s33, 1
    s_mov_b32 s15, 1
K_RECS:
    s_setprio 0
    v_and_b32 v14, s72, v10
    v_and_b32 v15, s72, v11
    v_and_b32 v16, s72, v12
    v_and_b32 v17, s72, v13
    v_lshlrev_b32 v10, 16, v10
    v_lshlrev_b32 v11, 16, v11
    v_lshlrev_b32 v12, 16, v12
    v_lshlrev_b32 v13, 16, v13
    v_mul_f32 v10, s77, v10
    v_mul_f32 v11, s77, v11
    v_mul_f32 v12, s77, v12
    v_mul_f32 v13, s77, v13
    v_mul_f32 v14, s77, v14
    v_mul_f32 v15, s77, v15
    v_mul_f32 v16, s77, v16
    v_mul_f32 v17, s77, v17
    v_lshrrev_b32 v2, 4, v6
    v_and_b32 v96, 15, v6
    v_lshlrev_b32 v102, 13, v2
    v_lshlrev_b32 v96, 1, v96
    v_add_u32 v104, v102, v96
    v_add_u32 v104, 6528, v104
    v_lshl_add_u32 v102, v96, 2, v102
    v_add_u32 v97, 1, v96
    v_add_u32 v98, 32, v96
    v_add_u32 v99, 33, v96
    v_lshlrev_b32 v103, 2, v2
    v_add_u32 v103, 162096, v103
    v_mov_b32 v3, 4
    v_mov_b32 v4, 65596
    s_mov_b64 s[12:13], 0
    v_mov_b32 v106, 0
    s_cmp_eq_u32 s33, 0
    s_cbranch_scc1 K_NOREP0
    s_waitcnt vmcnt(0)
    s_mov_b32 s1, 0x400000
SP_23:
    ds_read_b32 v5, v9 offset:12
    s_waitcnt lgkmcnt(0)
    v_readfirstlane_b32 s6, v5
    s_cmp_ge_u32 s6, 4
    s_cbranch_scc1 SPD_24
    s_sleep 1
    s_sub_u32 s1, s1, 1
    s_cbranch_scc0 SP_23
SPD_24:
    s_mov_b32 s33, 0
    s_mov_b64 exec, 1
    ds_add_rtn_u32 v2, v9, v7 offset:24
    s_mov_b64 exec, -1
    s_waitcnt lgkmcnt(0)
    v_readfirstlane_b32 s6, v2
    s_cmp_lg_u32 s6, 12
    s_cbranch_scc1 RP_25
    ds_read_b32 v25, v9 offset:36
    ds_read2_b32 v[26:27], v9 offset0:12 offset1:13
    s_lshl_b32 s6, s2, 7
    v_mov_b32 v2, s6
    s_mov_b64 exec, 1
    s_waitcnt lgkmcnt(0)
    v_lshl_or_b32 v25, v26, 1, v25
    v_mov_b32 v24, v27
    buffer_store_dwordx2 v[24:25], v2, s[64:67], 0 offen sc1
    s_mov_b64 exec, -1
RP_25:
K_NOREP0:
    s_mov_b32 s1, 0x400000
SP_26:
    ds_read_b32 v5, v9 offset:28
    s_waitcnt lgkmcnt(0)
    v_readfirstlane_b32 s6, v5
    s_cmp_ge_u32 s6, 1
    s_cbranch_scc1 SPD_27
    s_sleep 1
    s_sub_u32 s1, s1, 1
    s_cbranch_scc0 SP_26
SPD_27:
K_BATCH:
    s_mov_b64 exec, 1
    ds_add_rtn_u32 v2, v9, v7 offset:32
    s_mov_b64 exec, -1
    s_waitcnt lgkmcnt(0)
    v_readfirstlane_b32 s14, v2
    s_cmp_ge_u32 s14, 16
    s_cbranch_scc1 K_BDONE
    s_lshl_b32 s6, s14, 6
    v_add_u32 v101, s6, v103
    ds_read2_b32 v[44:45], v101 offset0:0 offset1:4
    ds_read2_b32 v[46:47], v101 offset0:8 offset1:12
    s_mul_i32 s6, s14, 131072
    v_add_u32 v100, s6, v102
    v_add_u32 v105, s6, v104
    v_mov_b32 v5, 64
    s_mov_b32 s79, 0
    s_waitcnt lgkmcnt(0)
K_AGAIN:
    s_mov_b64 s[10:11], 0
    v_mad_u32_u16 v88, v44, v3, v100
    v_mad_u32_u16 v92, v44, v7, v105
    v_cmp_lt_u32_sdwa s[16:17], v98, v44 src0_sel:DWORD src1_sel:WORD_1
    v_mad_u32_u16 v89, v45, v3, v100
    v_mad_u32_u16 v93, v45, v7, v105
    v_cmp_lt_u32_sdwa s[20:21], v98, v45 src0_sel:DWORD src1_sel:WORD_1
    v_mad_u32_u16 v90, v46, v3, v100
    v_mad_u32_u16 v94, v46, v7, v105
    v_cmp_lt_u32_sdwa s[24:25], v98, v46 src0_sel:DWORD src1_sel:WORD_1
    v_mad_u32_u16 v91, v47, v3, v100
    v_mad_u32_u16 v95, v47, v7, v105
    v_cmp_lt_u32_sdwa s[28:29], v98, v47 src0_sel:DWORD src1_sel:WORD_1
    s_cmp_eq_u64 s[16:17], 0
    s_cbranch_scc1 S2_28
    s_mov_b32 s6, 0
    buffer_load_dwordx2 v[56:57], v88, s[52:55], s6 offen offset:128
    buffer_load_ushort v68, v92, s[52:55], s6 offen offset:32
S2_28:
    s_cmp_eq_u64 s[20:21], 0
    s_cbranch_scc1 S2_29
    s_mov_b32 s6, 32768
    buffer_load_dwordx2 v[58:59], v89, s[52:55], s6 offen offset:128
    buffer_load_ushort v69, v93, s[52:55], s6 offen offset:32
S2_29:
    s_cmp_eq_u64 s[24:25], 0
    s_cbranch_scc1 S2_30
    s_mov_b32 s6, 65536
    buffer_load_dwordx2 v[60:61], v90, s[52:55], s6 offen offset:128
    buffer_load_ushort v70, v94, s[52:55], s6 offen offset:32
S2_30:
    s_cmp_eq_u64 s[28:29], 0
    s_cbranch_scc1 S2_31
    s_mov_b32 s6, 98304
    buffer_load_dwordx2 v[62:63], v91, s[52:55], s6 offen offset:128
    buffer_load_ushort v71, v95, s[52:55], s6 offen offset:32
S2_31:
    s_mov_b32 s6, 0
    buffer_load_dwordx2 v[48:49], v88, s[52:55], s6 offen
    buffer_load_ushort v64, v92, s[52:55], s6 offen
    s_mov_b32 s6, 32768
    buffer_load_dwordx2 v[50:51], v89, s[52:55], s6 offen
    buffer_load_ushort v65, v93, s[52:55], s6 offen
    s_mov_b32 s6, 65536
    buffer_load_dwordx2 v[52:53], v90, s[52:55], s6 offen
    buffer_load_ushort v66, v94, s[52:55], s6 offen
    s_mov_b32 s6, 98304
    buffer_load_dwordx2 v[54:55], v91, s[52:55], s6 offen
    buffer_load_ushort v67, v95, s[52:55], s6 offen
    v_cmp_lt_u32_sdwa s[80:81], v96, v44 src0_sel:DWORD src1_sel:WORD_1
    v_cmp_lt_u32_sdwa s[82:83], v97, v44 src0_sel:DWORD src1_sel:WORD_1
    v_cmp_lt_u32_sdwa s[18:19], v99, v44 src0_sel:DWORD src1_sel:WORD_1
    v_cmp_lt_u32_sdwa vcc, v5, v44 src0_sel:DWORD src1_sel:WORD_1
    s_or_b64 s[10:11], s[10:11], vcc
    v_cmp_lt_u32_sdwa s[84:85], v96, v45 src0_sel:DWORD src1_sel:WORD_1
    v_cmp_lt_u32_sdwa s[86:87], v97, v45 src0_sel:DWORD src1_sel:WORD_1
    v_cmp_lt_u32_sdwa s[22:23], v99, v45 src0_sel:DWORD src1_sel:WORD_1
    v_cmp_lt_u32_sdwa vcc, v5, v45 src0_sel:DWORD src1_sel:WORD_1
    s_or_b64 s[10:11], s[10:11], vcc
    v_cmp_lt_u32_sdwa s[88:89], v96, v46 src0_sel:DWORD src1_sel:WORD_1
    v_cmp_lt_u32_sdwa s[90:91], v97, v46 src0_sel:DWORD src1_sel:WORD_1
    v_cmp_lt_u32_sdwa s[26:27], v99, v46 src0_sel:DWORD src1_sel:WORD_1
    v_cmp_lt_u32_sdwa vcc, v5, v46 src0_sel:DWORD src1_sel:WORD_1
    s_or_b64 s[10:11], s[10:11], vcc
    v_cmp_lt_u32_sdwa s[92:93], v96, v47 src0_sel:DWORD src1_sel:WORD_1
    v_cmp_lt_u32_sdwa s[94:95], v97, v47 src0_sel:DWORD src1_sel:WORD_1
    v_cmp_lt_u32_sdwa s[30:31], v99, v47 src0_sel:DWORD src1_sel:WORD_1
    v_cmp_lt_u32_sdwa vcc, v5, v47 src0_sel:DWORD src1_sel:WORD_1
    s_or_b64 s[10:11], s[10:11], vcc
    s_cmp_eq_u32 s15, 0
    s_cbranch_scc1 XW_32
    s_mov_b32 s15, 0
    s_mov_b32 s1, 0x400000
SP_33:
    ds_read_b32 v28, v9 offset:56
    s_waitcnt lgkmcnt(0)
    v_readfirstlane_b32 s6, v28
    s_cmp_ge_u32 s6, 13
    s_cbranch_scc1 SPD_34
    s_sleep 1
    s_sub_u32 s1, s1, 1
    s_cbranch_scc0 SP_33
SPD_34:
    v_and_b32 v28, 31, v6
    s_lshl_b32 s6, s100, 5
    v_add_u32 v28, s6, v28
    v_cmp_gt_u32 vcc, 400, v28
    v_mul_u32_u24 v28, 80, v28
    v_lshrrev_b32 v29, 5, v6
    v_lshl_add_u32 v28, v29, 4, v28
    v_add_u32 v28, 125504, v28
    s_mov_b64 exec, vcc
    ds_write_b128 v28, v[36:39]
    ds_write_b128 v28, v[40:43] offset:32
    s_mov_b64 exec, -1
XW_32:
    s_waitcnt vmcnt(0)
    s_mov_b32 s6, 158272
    v_bfe_u32 v72, v64, 0, 8
    v_bfe_u32 v88, v48, 14, 2
    v_bfe_i32 v80, v48, 14, 1
    v_lshl_or_b32 v88, v72, 2, v88
    v_lshl_add_u32 v80, v80, 3, 4
    v_lshl_add_u32 v88, v88, 2, s6
    v_bfe_u32 v73, v64, 8, 8
    v_bfe_u32 v89, v49, 14, 2
    v_bfe_i32 v81, v49, 14, 1
    v_lshl_or_b32 v89, v73, 2, v89
    v_lshl_add_u32 v81, v81, 3, 4
    v_lshl_add_u32 v89, v89, 2, s6
    v_bfe_u32 v74, v65, 0, 8
    v_bfe_u32 v90, v50, 14, 2
    v_bfe_i32 v82, v50, 14, 1
    v_lshl_or_b32 v90, v74, 2, v90
    v_lshl_add_u32 v82, v82, 3, 4
    v_lshl_add_u32 v90, v90, 2, s6
    v_bfe_u32 v75, v65, 8, 8
    v_bfe_u32 v91, v51, 14, 2
    v_bfe_i32 v83, v51, 14, 1
    v_lshl_or_b32 v91, v75, 2, v91
    v_lshl_add_u32 v83, v83, 3, 4
    v_lshl_add_u32 v91, v91, 2, s6
    v_bfe_u32 v76, v66, 0, 8
    v_bfe_u32 v92, v52, 14, 2
    v_bfe_i32 v84, v52, 14, 1
    v_lshl_or_b32 v92, v76, 2, v92
    v_lshl_add_u32 v84, v84, 3, 4
    v_lshl_add_u32 v92, v92, 2, s6
    v_bfe_u32 v77, v66, 8, 8
    v_bfe_u32 v93, v53, 14, 2
    v_bfe_i32 v85, v53, 14, 1
    v_lshl_or_b32 v93, v77, 2, v93
    v_lshl_add_u32 v85, v85, 3, 4
    v_lshl_add_u32 v93, v93, 2, s6
    v_bfe_u32 v78, v67, 0, 8
    v_bfe_u32 v94, v54, 14, 2
    v_bfe_i32 v86, v54, 14, 1
    v_lshl_or_b32 v94, v78, 2, v94
    v_lshl_add_u32 v86, v86, 3, 4
    v_lshl_add_u32 v94, v94, 2, s6
    v_bfe_u32 v79, v67, 8, 8
    v_bfe_u32 v95, v55, 14, 2
    v_bfe_i32 v87, v55, 14, 1
    v_lshl_or_b32 v95, v79, 2, v95
    v_lshl_add_u32 v87, v87, 3, 4
    v_lshl_add_u32 v95, v95, 2, s6
    s_mov_b64 exec, s[80:81]
    ds_add_rtn_u32 v80, v88, v80
    v_and_b32 v48, 0xffff7fff, v48
    v_max_f32 v106, |v48|, v106
    s_mov_b64 exec, s[82:83]
    ds_add_rtn_u32 v81, v89, v81
    v_and_b32 v49, 0xffff7fff, v49
    v_max_f32 v106, |v49|, v106
    s_mov_b64 exec, s[84:85]
    ds_add_rtn_u32 v82, v90, v82
    v_and_b32 v50, 0xffff7fff, v50
    v_max_f32 v106, |v50|, v106
    s_mov_b64 exec, s[86:87]
    ds_add_rtn_u32 v83, v91, v83
    v_and_b32 v51, 0xffff7fff, v51
    v_max_f32 v106, |v51|, v106
    s_mov_b64 exec, s[88:89]
    ds_add_rtn_u32 v84, v92, v84
    v_and_b32 v52, 0xffff7fff, v52
    v_max_f32 v106, |v52|, v106
    s_mov_b64 exec, s[90:91]
    ds_add_rtn_u32 v85, v93, v85
    v_and_b32 v53, 0xffff7fff, v53
    v_max_f32 v106, |v53|, v106
    s_mov_b64 exec, s[92:93]
    ds_add_rtn_u32 v86, v94, v86
    v_and_b32 v54, 0xffff7fff, v54
    v_max_f32 v106, |v54|, v106
    s_mov_b64 exec, s[94:95]
    ds_add_rtn_u32 v87, v95, v87
    v_and_b32 v55, 0xffff7fff, v55
    v_max_f32 v106, |v55|, v106
    s_mov_b64 exec, s[80:81]
    s_waitcnt lgkmcnt(7)
    v_min_u32 v80, v4, v80
    ds_write_b32 v80, v48 offset:0
    s_mov_b64 exec, s[82:83]
    s_waitcnt lgkmcnt(7)
    v_min_u32 v81, v4, v81
    ds_write_b32 v81, v49 offset:0
    s_mov_b64 exec, s[84:85]
    s_waitcnt lgkmcnt(7)
    v_min_u32 v82, v4, v82
    ds_write_b32 v82, v50 offset:0
    s_mov_b64 exec, s[86:87]
    s_waitcnt lgkmcnt(7)
    v_min_u32 v83, v4, v83
    ds_write_b32 v83, v51 offset:0
    s_mov_b64 exec, s[88:89]
    s_waitcnt lgkmcnt(7)
    v_min_u32 v84, v4, v84
    ds_write_b32 v84, v52 offset:0
    s_mov_b64 exec, s[90:91]
    s_waitcnt lgkmcnt(7)
    v_min_u32 v85, v4, v85
    ds_write_b32 v85, v53 offset:0
    s_mov_b64 exec, s[92:93]
    s_waitcnt lgkmcnt(7)
    v_min_u32 v86, v4, v86
    ds_write_b32 v86, v54 offset:0
    s_mov_b64 exec, s[94:95]
    s_waitcnt lgkmcnt(7)
    v_min_u32 v87, v4, v87
    ds_write_b32 v87, v55 offset:0
    s_mov_b64 exec, -1
    s_cmp_eq_u64 s[16:17], 0
    s_cbranch_scc1 P2_35
    s_mov_b32 s6, 158272
    v_bfe_u32 v72, v68, 0, 8
    v_bfe_u32 v88, v56, 14, 2
    v_bfe_i32 v80, v56, 14, 1
    v_lshl_or_b32 v88, v72, 2, v88
    v_lshl_add_u32 v80, v80, 3, 4
    v_lshl_add_u32 v88, v88, 2, s6
    v_bfe_u32 v73, v68, 8, 8
    v_bfe_u32 v89, v57, 14, 2
    v_bfe_i32 v81, v57, 14, 1
    v_lshl_or_b32 v89, v73, 2, v89
    v_lshl_add_u32 v81, v81, 3, 4
    v_lshl_add_u32 v89, v89, 2, s6
    s_mov_b64 exec, s[16:17]
    ds_add_rtn_u32 v80, v88, v80
    v_and_b32 v56, 0xffff7fff, v56
    v_max_f32 v106, |v56|, v106
    s_mov_b64 exec, s[18:19]
    ds_add_rtn_u32 v81, v89, v81
    v_and_b32 v57, 0xffff7fff, v57
    v_max_f32 v106, |v57|, v106
    s_mov_b64 exec, s[16:17]
    s_waitcnt lgkmcnt(1)
    v_min_u32 v80, v4, v80
    ds_write_b32 v80, v56 offset:0
    s_mov_b64 exec, s[18:19]
    s_waitcnt lgkmcnt(1)
    v_min_u32 v81, v4, v81
    ds_write_b32 v81, v57 offset:0
    s_mov_b64 exec, -1
P2_35:
    s_cmp_eq_u64 s[20:21], 0
    s_cbranch_scc1 P2_36
    s_mov_b32 s6, 158272
    v_bfe_u32 v74, v69, 0, 8
    v_bfe_u32 v90, v58, 14, 2
    v_bfe_i32 v82, v58, 14, 1
    v_lshl_or_b32 v90, v74, 2, v90
    v_lshl_add_u32 v82, v82, 3, 4
    v_lshl_add_u32 v90, v90, 2, s6
    v_bfe_u32 v75, v69, 8, 8
    v_bfe_u32 v91, v59, 14, 2
    v_bfe_i32 v83, v59, 14, 1
    v_lshl_or_b32 v91, v75, 2, v91
    v_lshl_add_u32 v83, v83, 3, 4
    v_lshl_add_u32 v91, v91, 2, s6
    s_mov_b64 exec, s[20:21]
    ds_add_rtn_u32 v82, v90, v82
    v_and_b32 v58, 0xffff7fff, v58
    v_max_f32 v106, |v58|, v106
    s_mov_b64 exec, s[22:23]
    ds_add_rtn_u32 v83, v91, v83
    v_and_b32 v59, 0xffff7fff, v59
    v_max_f32 v106, |v59|, v106
    s_mov_b64 exec, s[20:21]
    s_waitcnt lgkmcnt(1)
    v_min_u32 v82, v4, v82
    ds_write_b32 v82, v58 offset:0
    s_mov_b64 exec, s[22:23]
    s_waitcnt lgkmcnt(1)
    v_min_u32 v83, v4, v83
    ds_write_b32 v83, v59 offset:0
    s_mov_b64 exec, -1
P2_36:
    s_cmp_eq_u64 s[24:25], 0
    s_cbranch_scc1 P2_37
    s_mov_b32 s6, 158272
    v_bfe_u32 v76, v70, 0, 8
    v_bfe_u32 v92, v60, 14, 2
    v_bfe_i32 v84, v60, 14, 1
    v_lshl_or_b32 v92, v76, 2, v92
    v_lshl_add_u32 v84, v84, 3, 4
    v_lshl_add_u32 v92, v92, 2, s6
    v_bfe_u32 v77, v70, 8, 8
    v_bfe_u32 v93, v61, 14, 2
    v_bfe_i32 v85, v61, 14, 1
    v_lshl_or_b32 v93, v77, 2, v93
    v_lshl_add_u32 v85, v85, 3, 4
    v_lshl_add_u32 v93, v93, 2, s6
    s_mov_b64 exec, s[24:25]
    ds_add_rtn_u32 v84, v92, v84
    v_and_b32 v60, 0xffff7fff, v60
    v_max_f32 v106, |v60|, v106
    s_mov_b64 exec, s[26:27]
    ds_add_rtn_u32 v85, v93, v85
    v_and_b32 v61, 0xffff7fff, v61
    v_max_f32 v106, |v61|, v106
    s_mov_b64 exec, s[24:25]
    s_waitcnt lgkmcnt(1)
    v_min_u32 v84, v4, v84
    ds_write_b32 v84, v60 offset:0
    s_mov_b64 exec, s[26:27]
    s_waitcnt lgkmcnt(1)
    v_min_u32 v85, v4, v85
    ds_write_b32 v85, v61 offset:0
    s_mov_b64 exec, -1
P2_37:
    s_cmp_eq_u64 s[28:29], 0
    s_cbranch_scc1 P2_38
    s_mov_b32 s6, 158272
    v_bfe_u32 v78, v71, 0, 8
    v_bfe_u32 v94, v62, 14, 2
    v_bfe_i32 v86, v62, 14, 1
    v_lshl_or_b32 v94, v78, 2, v94
    v_lshl_add_u32 v86, v86, 3, 4
    v_lshl_add_u32 v94, v94, 2, s6
    v_bfe_u32 v79, v71, 8, 8
    v_bfe_u32 v95, v63, 14, 2
    v_bfe_i32 v87, v63, 14, 1
    v_lshl_or_b32 v95, v79, 2, v95
    v_lshl_add_u32 v87, v87, 3, 4
    v_lshl_add_u32 v95, v95, 2, s6
    s_mov_b64 exec, s[28:29]
    ds_add_rtn_u32 v86, v94, v86
    v_and_b32 v62, 0xffff7fff, v62
    v_max_f32 v106, |v62|, v106
    s_mov_b64 exec, s[30:31]
    ds_add_rtn_u32 v87, v95, v87
    v_and_b32 v63, 0xffff7fff, v63
    v_max_f32 v106, |v63|, v106
    s_mov_b64 exec, s[28:29]
    s_waitcnt lgkmcnt(1)
    v_min_u32 v86, v4, v86
    ds_write_b32 v86, v62 offset:0
    s_mov_b64 exec, s[30:31]
    s_waitcnt lgkmcnt(1)
    v_min_u32 v87, v4, v87
    ds_write_b32 v87, v63 offset:0
    s_mov_b64 exec, -1
P2_38:
    s_cmp_lg_u64 s[10:11], 0
    s_cbranch_scc1 K_MORE
    s_cmp_eq_u32 s79, 0
    s_cbranch_scc1 K_BATCH
    v_subrev_u32 v96, s79, v96
    v_subrev_u32 v97, s79, v97
    v_subrev_u32 v98, s79, v98
    v_subrev_u32 v99, s79, v99
    s_branch K_BATCH
K_MORE:
    s_add_u32 s79, s79, 64
    v_add_u32 v96, 64, v96
    v_add_u32 v97, 64, v97
    v_add_u32 v98, 64, v98
    v_add_u32 v99, 64, v99
    v_add_u32 v5, 64, v5
    v_add_u32 v100, 0x100, v100
    v_add_u32 v105, 64, v105
    s_branch K_AGAIN
K_BDONE:
    s_cmp_eq_u32 s15, 0
    s_cbranch_scc1 XW_39
    s_mov_b32 s15, 0
    s_mov_b32 s1, 0x400000
SP_40:
    ds_read_b32 v28, v9 offset:56
    s_waitcnt lgkmcnt(0)
    v_readfirstlane_b32 s6, v28
    s_cmp_ge_u32 s6, 13
    s_cbranch_scc1 SPD_41
    s_sleep 1
    s_sub_u32 s1, s1, 1
    s_cbranch_scc0 SP_40
SPD_41:
    v_and_b32 v28, 31, v6
    s_lshl_b32 s6, s100, 5
    v_add_u32 v28, s6, v28
    v_cmp_gt_u32 vcc, 400, v28
    v_mul_u32_u24 v28, 80, v28
    v_lshrrev_b32 v29, 5, v6
    v_lshl_add_u32 v28, v29, 4, v28
    v_add_u32 v28, 125504, v28
    s_mov_b64 exec, vcc
    ds_write_b128 v28, v[36:39]
    ds_write_b128 v28, v[40:43] offset:32
    s_mov_b64 exec, -1
XW_39:
    v_max3_f32 v2, |v10|, |v11|, |v12|
    v_max3_f32 v2, v2, |v13|, |v14|
    v_max3_f32 v2, v2, |v15|, |v16|
    v_max_f32 v2, |v17|, v2
    s_nop 1
    v_max_f32_dpp v2, v2, v2 quad_perm:[1,0,3,2] row_mask:0xf bank_mask:0xf
    s_nop 1
    v_max_f32_dpp v2, v2, v2 quad_perm:[2,3,0,1] row_mask:0xf bank_mask:0xf
    v_mul_f32 v2, v2, v106
    v_cmp_lt_f32 vcc, 0x41c40000, v2
    s_cbranch_vccz K_NOSAFE
    ds_write_b32 v9, v7 offset:44
K_NOSAFE:
    s_cmp_eq_u64 s[12:13], 0
    s_cbranch_scc1 K_NOSLOW
    ds_write_b32 v9, v7 offset:40
K_NOSLOW:
    s_waitcnt lgkmcnt(0)
    s_barrier
    s_cmp_lg_u32 s3, 15
    s_cbranch_scc1 K_NOPI
    ds_read_b32 v2, v9 offset:36
    s_lshl_b32 s6, s4, 7
    v_lshl_add_u32 v3, v6, 9, s6
    s_mov_b64 s[16:17], -1
    s_mov_b64 exec, s[16:17]
    s_cbranch_execz PA_42
    s_mov_b32 s6, 0
    buffer_load_dwordx2 v[52:53], v3, s[64:67], s6 offen sc1
PA_42:
    s_mov_b64 exec, -1
    s_waitcnt lgkmcnt(0)
    v_readfirstlane_b32 s32, v2
K_NOPI:
    s_movk_i32 s6, 400
    v_cmp_gt_u32 s[10:11], s6, v0
    v_lshlrev_b32 v2, 3, v0
    v_add_u32 v2, 158272, v2
    s_mov_b64 exec, s[10:11]
    ds_read_b64 v[50:51], v2
    ds_read_b32 v47, v2 offset:12
    s_waitcnt lgkmcnt(0)
    v_add_u32 v51, 4, v51
    v_add_u32 v47, 4, v47
    v_sub_u32 v44, v50, v51
    v_lshrrev_b32 v44, 2, v44
    v_cmp_gt_i32 vcc, v50, v47
    v_cmp_gt_i32 s[8:9], 0, v51
    s_or_b64 vcc, vcc, s[8:9]
    v_cmp_lt_u32 s[8:9], 63, v44
    s_or_b64 vcc, vcc, s[8:9]
    s_cbranch_vccz K_FITS
    ds_write_b32 v9, v7 offset:40
K_FITS:
    v_min_u32 v44, 63, v44
    v_sub_u32 v45, 63, v44
    v_lshlrev_b32 v45, 2, v45
    v_add_u32 v2, 161504, v45
    ds_add_rtn_u32 v46, v2, v7
    s_mov_b64 exec, -1
    s_waitcnt lgkmcnt(0)
    s_barrier
    s_cmp_lg_u32 s3, 15
    s_cbranch_scc1 K_NOPOLLB
    s_mov_b32 s1, 0x100000
    s_branch TPC_44
TP_43:
    s_mov_b64 exec, s[16:17]
    s_cbranch_execz PA_46
    s_mov_b32 s6, 0
    buffer_load_dwordx2 v[52:53], v3, s[64:67], s6 offen sc1
PA_46:
    s_mov_b64 exec, -1
TPC_44:
    s_waitcnt vmcnt(0)
    v_and_b32 v4, -3, v53
    v_cmp_ne_u32 s[16:17], s32, v4
    s_mov_b64 vcc, s[16:17]
    s_cbranch_vccz TPD_45
    s_sleep 2
    s_sub_u32 s1, s1, 1
    s_cbranch_scc0 TP_43
TPD_45:
    v_lshlrev_b32 v3, 2, v6
    v_add_u32 v3, 161760, v3
    ds_write_b32 v3, v52
    v_and_b32 v4, 2, v53
    v_cmp_ne_u32 vcc, 0, v4
    s_cmp_lg_u64 vcc, 0
    s_cselect_b32 s6, 2, 1
    v_cmp_ne_u32 vcc, 0, v52
    s_cmp_lg_u64 vcc, 0
    s_cselect_b32 s6, 3, s6
    v_mov_b32 v4, s6
    s_waitcnt lgkmcnt(0)
    ds_write_b32 v9, v4 offset:60
K_NOPOLLB:
    s_cmp_ge_u32 s3, 7
    s_cbranch_scc1 K_NOPERM
    v_lshlrev_b32 v2, 2, v6
    v_add_u32 v2, 161504, v2
    ds_read_b32 v47, v2
    s_waitcnt lgkmcnt(0)
    v_mov_b32 v48, v47
    s_nop 1
    v_add_u32_dpp v48, v48, v48 row_shr:1 row_mask:0xf bank_mask:0xf
    s_nop 1
    v_add_u32_dpp v48, v48, v48 row_shr:2 row_mask:0xf bank_mask:0xf
    s_nop 1
    v_add_u32_dpp v48, v48, v48 row_shr:4 row_mask:0xf bank_mask:0xf
    s_nop 1
    v_add_u32_dpp v48, v48, v48 row_shr:8 row_mask:0xf bank_mask:0xf
    s_nop 1
    v_add_u32_dpp v48, v48, v48 row_bcast:15 row_mask:0xa bank_mask:0xf
    s_nop 1
    v_add_u32_dpp v48, v48, v48 row_bcast:31 row_mask:0xc bank_mask:0xf
    v_sub_u32 v48, v48, v47
    ds_bpermute_b32 v2, v45, v48
    v_lshlrev_b32 v44, 26, v44
    v_lshl_or_b32 v44, v0, 17, v44
    v_or_b32 v44, v51, v44
    s_waitcnt lgkmcnt(0)
    v_add_lshl_u32 v2, v2, v46, 2
    v_add_u32 v2, 158272, v2
    s_mov_b64 exec, s[10:11]
    ds_write_b32 v2, v44
    s_mov_b64 exec, -1
    s_waitcnt lgkmcnt(0)
    s_mov_b64 exec, 1
    ds_add_u32 v9, v7 offset:64
    s_mov_b64 exec, -1
K_NOPERM:
    s_brev_b32 s79, 1
    s_movk_i32 s10, 128
    s_mul_i32 s6, s5, 100096
    v_add_u32 v1, s6, v8
    v_lshrrev_b32 v0, 2, v6
    v_lshlrev_b32 v0, 2, v0
    v_add_u32 v0, 158272, v0
    v_add_u32 v6, 65600, v8
    s_mov_b32 s26, 0x3f80
    s_mov_b32 s27, 0x3f800000
    s_mov_b32 s28, 0x358637bd
    s_mov_b32 s29, 0x358637bd
    s_mov_b32 s13, 1
    s_mov_b32 s30, 80
    v_mov_b64 v[116:117], 0
    v_mov_b64 v[118:119], 0
    s_mov_b32 s8, 0xdc68e091
    s_mov_b32 s9, 0x4b5af723
    s_lshl_b32 s6, s3, 2
    s_lshr_b64 s[8:9], s[8:9], s6
    s_and_b32 s6, s8, 15
    s_lshl_b32 s6, s6, 6
    v_add_u32 v4, s6, v0
    s_mov_b32 s1, 0x400000
SP_47:
    ds_read_b32 v120, v9 offset:64
    s_waitcnt lgkmcnt(0)
    v_readfirstlane_b32 s6, v120
    s_cmp_ge_u32 s6, 7
    s_cbranch_scc1 SPD_48
    s_sleep 1
    s_sub_u32 s1, s1, 1
    s_cbranch_scc0 SP_47
SPD_48:
    ds_read2_b32 v[76:77], v9 offset0:10 offset1:11
    ds_read_b32 v4, v4
    s_setprio 3
    s_waitcnt lgkmcnt(1)
    v_readfirstlane_b32 s12, v76
    v_readfirstlane_b32 s25, v77
    s_cmp_lg_u32 s12, 0
    s_cbranch_scc1 K_SLOW
    s_branch K_GRP1
K_GROUP:
    s_mov_b64 exec, 1
    ds_add_rtn_u32 v4, v9, v7 offset:0
    s_mov_b64 exec, -1
    s_waitcnt lgkmcnt(0)
    v_readfirstlane_b32 s6, v4
    s_cmp_ge_u32 s6, 9
    s_cbranch_scc1 K_DONE
    s_lshl_b32 s6, s6, 6
    v_add_u32 v4, s6, v0
    ds_read_b32 v4, v4 offset:1024
K_GRP1:
    s_waitcnt lgkmcnt(0)
    v_and_b32 v42, 0x1ffff, v4
    v_lshrrev_b32 v5, 26, v4
    v_bfe_u32 v4, v4, 17, 9
    ds_read2_b32 v[108:109], v42 offset0:0 offset1:1
    v_mul_u32_u24 v2, 144, v4
    v_add_u32 v92, v2, v6
    ds_read_b128 v[34:37], v92
    ds_read_u16_d16_hi v116, v42 offset:2
    ds_read_u16_d16_hi v117, v42 offset:6
    ds_read2_b32 v[110:111], v42 offset0:2 offset1:3
    ds_read_u16_d16_hi v118, v42 offset:10
    ds_read_u16_d16_hi v119, v42 offset:14
    ds_read_b128 v[120:123], v92 offset:64
    v_mad_u32_u24 v2, v4, s30, v6
    ds_read_b128 v[124:127], v2 offset:59904
    v_readlane_b32 s15, v5, 0
    v_readlane_b32 s78, v5, 63
    v_lshl_add_u32 v43, v4, 8, v1
    v_sub_u32 v4, 390, v4
    v_and_or_b32 v43, v4, s79, v43
    s_mov_b32 s14, 0
    s_sub_u32 s11, s15, 2
    s_sub_u32 s24, s15, 6
    s_cmp_lg_u32 s13, 0
    s_cbranch_scc1 K_FIRST
K_GEN:
    s_waitcnt lgkmcnt(8)
    v_mad_u32_u16 v2, v108, s10, v8
    v_mad_u32_u16 v3, v109, s10, v8
    buffer_load_dwordx4 v[44:47], v2, s[48:51], 0 offen
    buffer_load_dwordx4 v[48:51], v2, s[48:51], 0 offen offset:64
    buffer_load_dwordx4 v[52:55], v3, s[48:51], 0 offen
    buffer_load_dwordx4 v[56:59], v3, s[48:51], 0 offen offset:64
    s_waitcnt lgkmcnt(5)
    v_and_b32 v38, s72, v34
    v_and_b32 v39, s72, v35
    v_and_b32 v40, s72, v36
    v_and_b32 v41, s72, v37
    v_lshlrev_b32 v34, 16, v34
    v_lshlrev_b32 v35, 16, v35
    v_lshlrev_b32 v36, 16, v36
    v_lshlrev_b32 v37, 16, v37
    s_cmp_lg_u32 s25, 0
    s_cselect_b32 s78, 0, s78
    s_cmp_lt_u32 s78, 4
    s_cbranch_scc1 K_INIT
    s_waitcnt lgkmcnt(4)
    v_mad_u32_u16 v2, v110, s10, v8
    v_mad_u32_u16 v3, v111, s10, v8
    buffer_load_dwordx4 v[60:63], v2, s[48:51], 0 offen
    buffer_load_dwordx4 v[64:67], v2, s[48:51], 0 offen offset:64
    buffer_load_dwordx4 v[68:71], v3, s[48:51], 0 offen
    buffer_load_dwordx4 v[72:75], v3, s[48:51], 0 offen offset:64
    v_pk_fma_f32 v[18:19], v[116:117], v[10:11], v[34:35] op_sel_hi:[0,1,1]
    v_pk_fma_f32 v[20:21], v[116:117], v[12:13], v[36:37] op_sel_hi:[0,1,1]
    v_pk_fma_f32 v[22:23], v[116:117], v[14:15], v[38:39] op_sel_hi:[0,1,1]
    v_pk_fma_f32 v[24:25], v[116:117], v[16:17], v[40:41] op_sel_hi:[0,1,1]
    v_pk_fma_f32 v[26:27], v[116:117], v[10:11], v[34:35] op_sel:[1,0,0] op_sel_hi:[1,1,1]
    v_pk_fma_f32 v[28:29], v[116:117], v[12:13], v[36:37] op_sel:[1,0,0] op_sel_hi:[1,1,1]
    v_pk_fma_f32 v[30:31], v[116:117], v[14:15], v[38:39] op_sel:[1,0,0] op_sel_hi:[1,1,1]
    v_pk_fma_f32 v[32:33], v[116:117], v[16:17], v[40:41] op_sel:[1,0,0] op_sel_hi:[1,1,1]
    ds_read2_b32 v[108:109], v42 offset0:4 offset1:5
    ds_read_u16_d16_hi v116, v42 offset:18
    ds_read_u16_d16_hi v117, v42 offset:22
    v_exp_f32 v18, v18
    v_exp_f32 v19, v19
    v_exp_f32 v20, v20
    v_exp_f32 v21, v21
    v_exp_f32 v22, v22
    v_exp_f32 v23, v23
    v_exp_f32 v24, v24
    v_exp_f32 v25, v25
    v_exp_f32 v26, v26
    v_exp_f32 v27, v27
    v_exp_f32 v28, v28
    v_exp_f32 v29, v29
    v_exp_f32 v30, v30
    v_exp_f32 v31, v31
    v_exp_f32 v32, v32
    v_exp_f32 v33, v33
    s_waitcnt vmcnt(4)
    v_pk_fma_f32 v[22:23], v[22:23], v[44:45], 1.0 op_sel_hi:[1,1,0]
    v_pk_fma_f32 v[24:25], v[24:25], v[46:47], 1.0 op_sel_hi:[1,1,0]
    v_lshlrev_b64 v[44:45], 16, v[44:45]
    v_lshlrev_b64 v[46:47], 16, v[46:47]
    v_pk_fma_f32 v[30:31], v[30:31], v[52:53], 1.0 op_sel_hi:[1,1,0]
    v_pk_fma_f32 v[32:33], v[32:33], v[54:55], 1.0 op_sel_hi:[1,1,0]
    v_lshlrev_b64 v[52:53], 16, v[52:53]
    v_lshlrev_b64 v[54:55], 16, v[54:55]
    v_pk_fma_f32 v[18:19], v[18:19], v[44:45], 1.0 op_sel_hi:[1,1,0]
    v_pk_fma_f32 v[20:21], v[20:21], v[46:47], 1.0 op_sel_hi:[1,1,0]
    v_lshlrev_b64 v[44:45], 16, v[48:49]
    v_lshlrev_b64 v[46:47], 16, v[50:51]
    v_pk_fma_f32 v[26:27], v[26:27], v[52:53], 1.0 op_sel_hi:[1,1,0]
    v_pk_fma_f32 v[28:29], v[28:29], v[54:55], 1.0 op_sel_hi:[1,1,0]
    v_lshlrev_b64 v[52:53], 16, v[56:57]
    v_lshlrev_b64 v[54:55], 16, v[58:59]
    v_pk_mul_f32 v[48:49], v[48:49], v[30:31]
    v_pk_mul_f32 v[50:51], v[50:51], v[32:33]
    v_pk_mul_f32 v[44:45], v[44:45], v[26:27]
    v_pk_mul_f32 v[46:47], v[46:47], v[28:29]
    v_pk_fma_f32 v[48:49], v[56:57], v[22:23], v[48:49]
    v_pk_fma_f32 v[50:51], v[58:59], v[24:25], v[50:51]
    v_pk_fma_f32 v[44:45], v[52:53], v[18:19], v[44:45]
    v_pk_fma_f32 v[46:47], v[54:55], v[20:21], v[46:47]
    v_pk_mul_f32 v[56:57], v[22:23], v[30:31]
    v_pk_mul_f32 v[58:59], v[24:25], v[32:33]
    v_pk_mul_f32 v[52:53], v[18:19], v[26:27]
    v_pk_mul_f32 v[54:55], v[20:21], v[28:29]
    v_pk_add_f32 v[22:23], v[22:23], v[30:31]
    v_pk_add_f32 v[24:25], v[24:25], v[32:33]
    v_pk_add_f32 v[18:19], v[18:19], v[26:27]
    v_pk_add_f32 v[20:21], v[20:21], v[28:29]
    v_rcp_f32 v56, v56
    v_rcp_f32 v57, v57
    v_rcp_f32 v58, v58
    v_rcp_f32 v59, v59
    v_rcp_f32 v52, v52
    v_rcp_f32 v53, v53
    v_rcp_f32 v54, v54
    v_rcp_f32 v55, v55
    v_pk_mul_f32 v[30:31], v[48:49], v[56:57]
    v_pk_mul_f32 v[32:33], v[50:51], v[58:59]
    v_pk_mul_f32 v[26:27], v[44:45], v[52:53]
    v_pk_mul_f32 v[28:29], v[46:47], v[54:55]
    v_pk_fma_f32 v[22:23], v[22:23], v[56:57], s[28:29]
    v_pk_fma_f32 v[24:25], v[24:25], v[58:59], s[28:29]
    v_pk_fma_f32 v[18:19], v[18:19], v[52:53], s[28:29]
    v_pk_fma_f32 v[20:21], v[20:21], v[54:55], s[28:29]
    s_branch K_NEXT0
K_INIT:
    v_mov_b32 v18, 0x358637bd
    v_mov_b32 v19, v18
    v_mov_b64 v[20:21], v[18:19]
    v_mov_b64 v[22:23], v[18:19]
    v_mov_b64 v[24:25], v[18:19]
    v_mov_b64 v[26:27], 0
    v_mov_b64 v[28:29], 0
    v_mov_b64 v[30:31], 0
    v_mov_b64 v[32:33], 0
    s_cmp_eq_u32 s15, 0
    s_cbranch_scc1 K_EPI0
K_TOP0:
    s_cmp_ge_i32 s14, s24
    s_cbranch_scc1 K_PRI0
K_PRB0:
    s_cmp_lt_i32 s14, s11
    s_cbranch_scc0 K_NOG0
    s_waitcnt lgkmcnt(0)
    v_mad_u32_u16 v2, v110, s10, v8
    v_mad_u32_u16 v3, v111, s10, v8
    buffer_load_dwordx4 v[60:63], v2, s[48:51], 0 offen
    buffer_load_dwordx4 v[64:67], v2, s[48:51], 0 offen offset:64
    buffer_load_dwordx4 v[68:71], v3, s[48:51], 0 offen
    buffer_load_dwordx4 v[72:75], v3, s[48:51], 0 offen offset:64
    s_cmp_lg_u32 s25, 0
    v_pk_fma_f32 v[76:77], v[116:117], v[10:11], v[34:35] op_sel_hi:[0,1,1]
    v_pk_fma_f32 v[78:79], v[116:117], v[12:13], v[36:37] op_sel_hi:[0,1,1]
    v_pk_fma_f32 v[80:81], v[116:117], v[14:15], v[38:39] op_sel_hi:[0,1,1]
    v_pk_fma_f32 v[82:83], v[116:117], v[16:17], v[40:41] op_sel_hi:[0,1,1]
    v_pk_fma_f32 v[84:85], v[116:117], v[10:11], v[34:35] op_sel:[1,0,0] op_sel_hi:[1,1,1]
    v_pk_fma_f32 v[86:87], v[116:117], v[12:13], v[36:37] op_sel:[1,0,0] op_sel_hi:[1,1,1]
    v_pk_fma_f32 v[88:89], v[116:117], v[14:15], v[38:39] op_sel:[1,0,0] op_sel_hi:[1,1,1]
    v_pk_fma_f32 v[90:91], v[116:117], v[16:17], v[40:41] op_sel:[1,0,0] op_sel_hi:[1,1,1]
    ds_read2_b32 v[108:109], v42 offset0:4 offset1:5
    ds_read_u16_d16_hi v116, v42 offset:18
    ds_read_u16_d16_hi v117, v42 offset:22
    s_cbranch_scc1 K_NOX0
    v_exp_f32 v76, v76
    v_exp_f32 v77, v77
    v_exp_f32 v78, v78
    v_exp_f32 v79, v79
    v_exp_f32 v80, v80
    v_exp_f32 v81, v81
    v_exp_f32 v82, v82
    v_exp_f32 v83, v83
    v_exp_f32 v84, v84
    v_exp_f32 v85, v85
    v_exp_f32 v86, v86
    v_exp_f32 v87, v87
    v_exp_f32 v88, v88
    v_exp_f32 v89, v89
    v_exp_f32 v90, v90
    v_exp_f32 v91, v91
K_NOX0:
    s_waitcnt vmcnt(4)
K_GOT0:
    s_add_u32 s6, s14, 2
    s_cmp_le_u32 s6, s78
    s_cbranch_scc0 K_TAIL0
    v_pk_fma_f32 v[80:81], v[80:81], v[44:45], 1.0 op_sel_hi:[1,1,0]
    v_pk_fma_f32 v[82:83], v[82:83], v[46:47], 1.0 op_sel_hi:[1,1,0]
    v_lshlrev_b64 v[44:45], 16, v[44:45]
    v_lshlrev_b64 v[46:47], 16, v[46:47]
    v_pk_fma_f32 v[88:89], v[88:89], v[52:53], 1.0 op_sel_hi:[1,1,0]
    v_pk_fma_f32 v[90:91], v[90:91], v[54:55], 1.0 op_sel_hi:[1,1,0]
    v_lshlrev_b64 v[52:53], 16, v[52:53]
    v_lshlrev_b64 v[54:55], 16, v[54:55]
    v_pk_fma_f32 v[76:77], v[76:77], v[44:45], 1.0 op_sel_hi:[1,1,0]
    v_pk_fma_f32 v[78:79], v[78:79], v[46:47], 1.0 op_sel_hi:[1,1,0]
    v_lshlrev_b64 v[44:45], 16, v[48:49]
    v_lshlrev_b64 v[46:47], 16, v[50:51]
    v_pk_fma_f32 v[84:85], v[84:85], v[52:53], 1.0 op_sel_hi:[1,1,0]
    v_pk_fma_f32 v[86:87], v[86:87], v[54:55], 1.0 op_sel_hi:[1,1,0]
    v_lshlrev_b64 v[52:53], 16, v[56:57]
    v_lshlrev_b64 v[54:55], 16, v[58:59]
    v_pk_mul_f32 v[48:49], v[48:49], v[88:89]
    v_pk_mul_f32 v[50:51], v[50:51], v[90:91]
    v_pk_mul_f32 v[44:45], v[44:45], v[84:85]
    v_pk_mul_f32 v[46:47], v[46:47], v[86:87]
    v_pk_fma_f32 v[48:49], v[56:57], v[80:81], v[48:49]
    v_pk_fma_f32 v[50:51], v[58:59], v[82:83], v[50:51]
    v_pk_fma_f32 v[44:45], v[52:53], v[76:77], v[44:45]
    v_pk_fma_f32 v[46:47], v[54:55], v[78:79], v[46:47]
    v_pk_mul_f32 v[56:57], v[80:81], v[88:89]
    v_pk_mul_f32 v[58:59], v[82:83], v[90:91]
    v_pk_mul_f32 v[52:53], v[76:77], v[84:85]
    v_pk_mul_f32 v[54:55], v[78:79], v[86:87]
    v_pk_add_f32 v[80:81], v[80:81], v[88:89]
    v_pk_add_f32 v[82:83], v[82:83], v[90:91]
    v_pk_add_f32 v[76:77], v[76:77], v[84:85]
    v_pk_add_f32 v[78:79], v[78:79], v[86:87]
    v_rcp_f32 v56, v56
    v_rcp_f32 v57, v57
    v_rcp_f32 v58, v58
    v_rcp_f32 v59, v59
    v_rcp_f32 v52, v52
    v_rcp_f32 v53, v53
    v_rcp_f32 v54, v54
    v_rcp_f32 v55, v55
    v_pk_fma_f32 v[30:31], v[48:49], v[56:57], v[30:31]
    v_pk_fma_f32 v[32:33], v[50:51], v[58:59], v[32:33]
    v_pk_fma_f32 v[26:27], v[44:45], v[52:53], v[26:27]
    v_pk_fma_f32 v[28:29], v[46:47], v[54:55], v[28:29]
    v_pk_fma_f32 v[22:23], v[80:81], v[56:57], v[22:23]
    v_pk_fma_f32 v[24:25], v[82:83], v[58:59], v[24:25]
    v_pk_fma_f32 v[18:19], v[76:77], v[52:53], v[18:19]
    v_pk_fma_f32 v[20:21], v[78:79], v[54:55], v[20:21]
K_NEXT0:
    s_add_u32 s14, s14, 2
    s_cmp_ge_u32 s14, s15
    s_cbranch_scc1 K_EPI
K_TOP1:
    s_cmp_ge_i32 s14, s24
    s_cbranch_scc1 K_PRI1
K_PRB1:
    s_cmp_lt_i32 s14, s11
    s_cbranch_scc0 K_NOG1
    s_waitcnt lgkmcnt(0)
    v_mad_u32_u16 v2, v108, s10, v8
    v_mad_u32_u16 v3, v109, s10, v8
    buffer_load_dwordx4 v[44:47], v2, s[48:51], 0 offen
    buffer_load_dwordx4 v[48:51], v2, s[48:51], 0 offen offset:64
    buffer_load_dwordx4 v[52:55], v3, s[48:51], 0 offen
    buffer_load_dwordx4 v[56:59], v3, s[48:51], 0 offen offset:64
    s_cmp_lg_u32 s25, 0
    v_pk_fma_f32 v[76:77], v[118:119], v[10:11], v[34:35] op_sel_hi:[0,1,1]
    v_pk_fma_f32 v[78:79], v[118:119], v[12:13], v[36:37] op_sel_hi:[0,1,1]
    v_pk_fma_f32 v[80:81], v[118:119], v[14:15], v[38:39] op_sel_hi:[0,1,1]
    v_pk_fma_f32 v[82:83], v[118:119], v[16:17], v[40:41] op_sel_hi:[0,1,1]
    v_pk_fma_f32 v[84:85], v[118:119], v[10:11], v[34:35] op_sel:[1,0,0] op_sel_hi:[1,1,1]
    v_pk_fma_f32 v[86:87], v[118:119], v[12:13], v[36:37] op_sel:[1,0,0] op_sel_hi:[1,1,1]
    v_pk_fma_f32 v[88:89], v[118:119], v[14:15], v[38:39] op_sel:[1,0,0] op_sel_hi:[1,1,1]
    v_pk_fma_f32 v[90:91], v[118:119], v[16:17], v[40:41] op_sel:[1,0,0] op_sel_hi:[1,1,1]
    ds_read2_b32 v[110:111], v42 offset0:6 offset1:7
    ds_read_u16_d16_hi v118, v42 offset:26
    ds_read_u16_d16_hi v119, v42 offset:30
    v_add_u32 v42, 16, v42
    s_cbranch_scc1 K_NOX1
    v_exp_f32 v76, v76
    v_exp_f32 v77, v77
    v_exp_f32 v78, v78
    v_exp_f32 v79, v79
    v_exp_f32 v80, v80
    v_exp_f32 v81, v81
    v_exp_f32 v82, v82
    v_exp_f32 v83, v83
    v_exp_f32 v84, v84
    v_exp_f32 v85, v85
    v_exp_f32 v86, v86
    v_exp_f32 v87, v87
    v_exp_f32 v88, v88
    v_exp_f32 v89, v89
    v_exp_f32 v90, v90
    v_exp_f32 v91, v91
K_NOX1:
    s_waitcnt vmcnt(4)
K_GOT1:
    s_add_u32 s6, s14, 2
    s_cmp_le_u32 s6, s78
    s_cbranch_scc0 K_TAIL1
    v_pk_fma_f32 v[80:81], v[80:81], v[60:61], 1.0 op_sel_hi:[1,1,0]
    v_pk_fma_f32 v[82:83], v[82:83], v[62:63], 1.0 op_sel_hi:[1,1,0]
    v_lshlrev_b64 v[60:61], 16, v[60:61]
    v_lshlrev_b64 v[62:63], 16, v[62:63]
    v_pk_fma_f32 v[88:89], v[88:89], v[68:69], 1.0 op_sel_hi:[1,1,0]
    v_pk_fma_f32 v[90:91], v[90:91], v[70:71], 1.0 op_sel_hi:[1,1,0]
    v_lshlrev_b64 v[68:69], 16, v[68:69]
    v_lshlrev_b64 v[70:71], 16, v[70:71]
    v_pk_fma_f32 v[76:77], v[76:77], v[60:61], 1.0 op_sel_hi:[1,1,0]
    v_pk_fma_f32 v[78:79], v[78:79], v[62:63], 1.0 op_sel_hi:[1,1,0]
    v_lshlrev_b64 v[60:61], 16, v[64:65]
    v_lshlrev_b64 v[62:63], 16, v[66:67]
    v_pk_fma_f32 v[84:85], v[84:85], v[68:69], 1.0 op_sel_hi:[1,1,0]
    v_pk_fma_f32 v[86:87], v[86:87], v[70:71], 1.0 op_sel_hi:[1,1,0]
    v_lshlrev_b64 v[68:69], 16, v[72:73]
    v_lshlrev_b64 v[70:71], 16, v[74:75]
    v_pk_mul_f32 v[64:65], v[64:65], v[88:89]
    v_pk_mul_f32 v[66:67], v[66:67], v[90:91]
    v_pk_mul_f32 v[60:61], v[60:61], v[84:85]
    v_pk_mul_f32 v[62:63], v[62:63], v[86:87]
    v_pk_fma_f32 v[64:65], v[72:73], v[80:81], v[64:65]
    v_pk_fma_f32 v[66:67], v[74:75], v[82:83], v[66:67]
    v_pk_fma_f32 v[60:61], v[68:69], v[76:77], v[60:61]
    v_pk_fma_f32 v[62:63], v[70:71], v[78:79], v[62:63]
    v_pk_mul_f32 v[72:73], v[80:81], v[88:89]
    v_pk_mul_f32 v[74:75], v[82:83], v[90:91]
    v_pk_mul_f32 v[68:69], v[76:77], v[84:85]
    v_pk_mul_f32 v[70:71], v[78:79], v[86:87]
    v_pk_add_f32 v[80:81], v[80:81], v[88:89]
    v_pk_add_f32 v[82:83], v[82:83], v[90:91]
    v_pk_add_f32 v[76:77], v[76:77], v[84:85]
    v_pk_add_f32 v[78:79], v[78:79], v[86:87]
    v_rcp_f32 v72, v72
    v_rcp_f32 v73, v73
    v_rcp_f32 v74, v74
    v_rcp_f32 v75, v75
    v_rcp_f32 v68, v68
    v_rcp_f32 v69, v69
    v_rcp_f32 v70, v70
    v_rcp_f32 v71, v71
    v_pk_fma_f32 v[30:31], v[64:65], v[72:73], v[30:31]
    v_pk_fma_f32 v[32:33], v[66:67], v[74:75], v[32:33]
    v_pk_fma_f32 v[26:27], v[60:61], v[68:69], v[26:27]
    v_pk_fma_f32 v[28:29], v[62:63], v[70:71], v[28:29]
    v_pk_fma_f32 v[22:23], v[80:81], v[72:73], v[22:23]
    v_pk_fma_f32 v[24:25], v[82:83], v[74:75], v[24:25]
    v_pk_fma_f32 v[18:19], v[76:77], v[68:69], v[18:19]
    v_pk_fma_f32 v[20:21], v[78:79], v[70:71], v[20:21]
K_NEXT1:
    s_add_u32 s14, s14, 2
    s_cmp_ge_u32 s14, s15
    s_cbranch_scc0 K_TOP0
K_EPI:
    s_mov_b64 exec, -1
    s_waitcnt lgkmcnt(0)
    v_rcp_f32 v18, v18
    v_rcp_f32 v19, v19
    v_rcp_f32 v20, v20
    v_rcp_f32 v21, v21
    v_rcp_f32 v22, v22
    v_rcp_f32 v23, v23
    v_rcp_f32 v24, v24
    v_rcp_f32 v25, v25
    v_lshlrev_b32 v76, 16, v120
    v_and_b32 v120, s72, v120
    v_lshlrev_b32 v77, 16, v121
    v_and_b32 v121, s72, v121
    v_lshlrev_b32 v78, 16, v122
    v_and_b32 v122, s72, v122
    v_lshlrev_b32 v79, 16, v123
    v_and_b32 v123, s72, v123
    v_pk_fma_f32 v[76:77], v[26:27], v[18:19], v[76:77]
    v_pk_fma_f32 v[78:79], v[28:29], v[20:21], v[78:79]
    v_pk_fma_f32 v[120:121], v[30:31], v[22:23], v[120:121]
    v_pk_fma_f32 v[122:123], v[32:33], v[24:25], v[122:123]
    v_max_f32 v76, 0, v76
    v_max_f32 v77, 0, v77
    v_max_f32 v78, 0, v78
    v_max_f32 v79, 0, v79
    v_max_f32 v120, 0, v120
    v_max_f32 v121, 0, v121
    v_max_f32 v122, 0, v122
    v_max_f32 v123, 0, v123
    v_dot2_f32_bf16 v76, v124, s26, v76
    v_dot2_f32_bf16 v120, v124, s27, v120
    v_dot2_f32_bf16 v77, v125, s26, v77
    v_dot2_f32_bf16 v121, v125, s27, v121
    v_dot2_f32_bf16 v78, v126, s26, v78
    v_dot2_f32_bf16 v122, v126, s27, v122
    v_dot2_f32_bf16 v79, v127, s26, v79
    v_dot2_f32_bf16 v123, v127, s27, v123
    s_nop 2
    v_cvt_pk_bf16_f32 v84, v76, v120
    v_cvt_pk_bf16_f32 v85, v77, v121
    v_cvt_pk_bf16_f32 v86, v78, v122
    v_cvt_pk_bf16_f32 v87, v79, v123
    buffer_store_dwordx4 v[84:87], v43, s[60:63], s0 offen sc1
    s_setprio 2
    s_cmp_eq_u32 s12, 0
    s_cbranch_scc1 K_GROUP
    s_branch K_SNEXT
K_EPI0:
    s_waitcnt vmcnt(0)
    s_branch K_EPI
K_FIRST:
    s_cmp_ge_u32 s78, 8
    s_cselect_b32 s6, 1, 0
    s_cmp_gt_u32 s6, s25
    s_cbranch_scc1 K_DEEP
    s_mov_b32 s13, 0
    s_mov_b32 s1, 0x400000
SP_49:
    ds_read_b32 v2, v9 offset:60
    s_waitcnt lgkmcnt(0)
    v_readfirstlane_b32 s6, v2
    s_cmp_ge_u32 s6, 1
    s_cbranch_scc1 SPD_50
    s_sleep 1
    s_sub_u32 s1, s1, 1
    s_cbranch_scc0 SP_49
SPD_50:
    s_cmp_lg_u32 s6, 1
    s_cbranch_scc1 K_NOTFAST
    s_branch K_GEN
K_DEEP:
    ds_read_b32 v2, v9 offset:60
    ds_read2_b32 v[112:113], v42 offset0:4 offset1:5
    ds_read2_b32 v[114:115], v42 offset0:6 offset1:7
    s_waitcnt lgkmcnt(2)
    v_readfirstlane_b32 s13, v2
    s_cmp_lg_u32 s13, 1
    s_cbranch_scc1 K_DP1
    v_mad_u32_u16 v2, v108, s10, v8
    v_mad_u32_u16 v3, v109, s10, v8
    buffer_load_dwordx4 v[44:47], v2, s[48:51], 0 offen
    buffer_load_dwordx4 v[48:51], v2, s[48:51], 0 offen offset:64
    buffer_load_dwordx4 v[52:55], v3, s[48:51], 0 offen
    buffer_load_dwordx4 v[56:59], v3, s[48:51], 0 offen offset:64
    v_mad_u32_u16 v2, v110, s10, v8
    v_mad_u32_u16 v3, v111, s10, v8
    buffer_load_dwordx4 v[60:63], v2, s[48:51], 0 offen
    buffer_load_dwordx4 v[64:67], v2, s[48:51], 0 offen offset:64
    buffer_load_dwordx4 v[68:71], v3, s[48:51], 0 offen
    buffer_load_dwordx4 v[72:75], v3, s[48:51], 0 offen offset:64
K_DP1:
    v_and_b32 v38, s72, v34
    v_and_b32 v39, s72, v35
    v_and_b32 v40, s72, v36
    v_and_b32 v41, s72, v37
    v_lshlrev_b32 v34, 16, v34
    v_lshlrev_b32 v35, 16, v35
    v_lshlrev_b32 v36, 16, v36
    v_lshlrev_b32 v37, 16, v37
    v_pk_fma_f32 v[18:19], v[116:117], v[10:11], v[34:35] op_sel_hi:[0,1,1]
    v_pk_fma_f32 v[20:21], v[116:117], v[12:13], v[36:37] op_sel_hi:[0,1,1]
    v_pk_fma_f32 v[22:23], v[116:117], v[14:15], v[38:39] op_sel_hi:[0,1,1]
    v_pk_fma_f32 v[24:25], v[116:117], v[16:17], v[40:41] op_sel_hi:[0,1,1]
    v_pk_fma_f32 v[26:27], v[116:117], v[10:11], v[34:35] op_sel:[1,0,0] op_sel_hi:[1,1,1]
    v_pk_fma_f32 v[28:29], v[116:117], v[12:13], v[36:37] op_sel:[1,0,0] op_sel_hi:[1,1,1]
    v_pk_fma_f32 v[30:31], v[116:117], v[14:15], v[38:39] op_sel:[1,0,0] op_sel_hi:[1,1,1]
    v_pk_fma_f32 v[32:33], v[116:117], v[16:17], v[40:41] op_sel:[1,0,0] op_sel_hi:[1,1,1]
    ds_read_u16_d16_hi v116, v42 offset:18
    ds_read_u16_d16_hi v117, v42 offset:22
    v_exp_f32 v18, v18
    v_exp_f32 v19, v19
    v_exp_f32 v20, v20
    v_exp_f32 v21, v21
    v_exp_f32 v22, v22
    v_exp_f32 v23, v23
    v_exp_f32 v24, v24
    v_exp_f32 v25, v25
    v_exp_f32 v26, v26
    v_exp_f32 v27, v27
    v_exp_f32 v28, v28
    v_exp_f32 v29, v29
    v_exp_f32 v30, v30
    v_exp_f32 v31, v31
    v_exp_f32 v32, v32
    v_exp_f32 v33, v33
    s_cmp_eq_u32 s13, 1
    s_cbranch_scc1 K_DP2
    ds_read_b32 v2, v9 offset:60
    s_waitcnt lgkmcnt(0)
    v_readfirstlane_b32 s13, v2
    s_cmp_lg_u32 s13, 1
    s_cbranch_scc1 K_DP2
    v_mad_u32_u16 v2, v108, s10, v8
    v_mad_u32_u16 v3, v109, s10, v8
    buffer_load_dwordx4 v[44:47], v2, s[48:51], 0 offen
    buffer_load_dwordx4 v[48:51], v2, s[48:51], 0 offen offset:64
    buffer_load_dwordx4 v[52:55], v3, s[48:51], 0 offen
    buffer_load_dwordx4 v[56:59], v3, s[48:51], 0 offen offset:64
    v_mad_u32_u16 v2, v110, s10, v8
    v_mad_u32_u16 v3, v111, s10, v8
    buffer_load_dwordx4 v[60:63], v2, s[48:51], 0 offen
    buffer_load_dwordx4 v[64:67], v2, s[48:51], 0 offen offset:64
    buffer_load_dwordx4 v[68:71], v3, s[48:51], 0 offen
    buffer_load_dwordx4 v[72:75], v3, s[48:51], 0 offen offset:64
K_DP2:
    v_pk_fma_f32 v[92:93], v[118:119], v[10:11], v[34:35] op_sel_hi:[0,1,1]
    v_pk_fma_f32 v[94:95], v[118:119], v[12:13], v[36:37] op_sel_hi:[0,1,1]
    v_pk_fma_f32 v[96:97], v[118:119], v[14:15], v[38:39] op_sel_hi:[0,1,1]
    v_pk_fma_f32 v[98:99], v[118:119], v[16:17], v[40:41] op_sel_hi:[0,1,1]
    v_pk_fma_f32 v[100:101], v[118:119], v[10:11], v[34:35] op_sel:[1,0,0] op_sel_hi:[1,1,1]
    v_pk_fma_f32 v[102:103], v[118:119], v[12:13], v[36:37] op_sel:[1,0,0] op_sel_hi:[1,1,1]
    v_pk_fma_f32 v[104:105], v[118:119], v[14:15], v[38:39] op_sel:[1,0,0] op_sel_hi:[1,1,1]
    v_pk_fma_f32 v[106:107], v[118:119], v[16:17], v[40:41] op_sel:[1,0,0] op_sel_hi:[1,1,1]
    ds_read_u16_d16_hi v118, v42 offset:26
    ds_read_u16_d16_hi v119, v42 offset:30
    v_exp_f32 v92, v92
    v_exp_f32 v93, v93
    v_exp_f32 v94, v94
    v_exp_f32 v95, v95
    v_exp_f32 v96, v96
    v_exp_f32 v97, v97
    v_exp_f32 v98, v98
    v_exp_f32 v99, v99
    v_exp_f32 v100, v100
    v_exp_f32 v101, v101
    v_exp_f32 v102, v102
    v_exp_f32 v103, v103
    v_exp_f32 v104, v104
    v_exp_f32 v105, v105
    v_exp_f32 v106, v106
    v_exp_f32 v107, v107
    s_waitcnt lgkmcnt(0)
    v_pk_fma_f32 v[76:77], v[116:117], v[10:11], v[34:35] op_sel_hi:[0,1,1]
    v_pk_fma_f32 v[78:79], v[116:117], v[12:13], v[36:37] op_sel_hi:[0,1,1]
    v_pk_fma_f32 v[80:81], v[116:117], v[14:15], v[38:39] op_sel_hi:[0,1,1]
    v_pk_fma_f32 v[82:83], v[116:117], v[16:17], v[40:41] op_sel_hi:[0,1,1]
    v_pk_fma_f32 v[84:85], v[116:117], v[10:11], v[34:35] op_sel:[1,0,0] op_sel_hi:[1,1,1]
    v_pk_fma_f32 v[86:87], v[116:117], v[12:13], v[36:37] op_sel:[1,0,0] op_sel_hi:[1,1,1]
    v_pk_fma_f32 v[88:89], v[116:117], v[14:15], v[38:39] op_sel:[1,0,0] op_sel_hi:[1,1,1]
    v_pk_fma_f32 v[90:91], v[116:117], v[16:17], v[40:41] op_sel:[1,0,0] op_sel_hi:[1,1,1]
    ds_read_u16_d16_hi v116, v42 offset:34
    ds_read_u16_d16_hi v117, v42 offset:38
    v_exp_f32 v76, v76
    v_exp_f32 v77, v77
    v_exp_f32 v78, v78
    v_exp_f32 v79, v79
    v_exp_f32 v80, v80
    v_exp_f32 v81, v81
    v_exp_f32 v82, v82
    v_exp_f32 v83, v83
    v_exp_f32 v84, v84
    v_exp_f32 v85, v85
    v_exp_f32 v86, v86
    v_exp_f32 v87, v87
    v_exp_f32 v88, v88
    v_exp_f32 v89, v89
    v_exp_f32 v90, v90
    v_exp_f32 v91, v91
    s_cmp_eq_u32 s13, 1
    s_cbranch_scc1 K_DP3
    s_mov_b32 s13, 0
    s_mov_b32 s1, 0x400000
SP_51:
    ds_read_b32 v2, v9 offset:60
    s_waitcnt lgkmcnt(0)
    v_readfirstlane_b32 s6, v2
    s_cmp_ge_u32 s6, 1
    s_cbranch_scc1 SPD_52
    s_sleep 1
    s_sub_u32 s1, s1, 1
    s_cbranch_scc0 SP_51
SPD_52:
    s_cmp_lg_u32 s6, 1
    s_cbranch_scc1 K_NOTFAST
    v_mad_u32_u16 v2, v108, s10, v8
    v_mad_u32_u16 v3, v109, s10, v8
    buffer_load_dwordx4 v[44:47], v2, s[48:51], 0 offen
    buffer_load_dwordx4 v[48:51], v2, s[48:51], 0 offen offset:64
    buffer_load_dwordx4 v[52:55], v3, s[48:51], 0 offen
    buffer_load_dwordx4 v[56:59], v3, s[48:51], 0 offen offset:64
    v_mad_u32_u16 v2, v110, s10, v8
    v_mad_u32_u16 v3, v111, s10, v8
    buffer_load_dwordx4 v[60:63], v2, s[48:51], 0 offen
    buffer_load_dwordx4 v[64:67], v2, s[48:51], 0 offen offset:64
    buffer_load_dwordx4 v[68:71], v3, s[48:51], 0 offen
    buffer_load_dwordx4 v[72:75], v3, s[48:51], 0 offen offset:64
K_DP3:
    s_mov_b32 s13, 0
    ds_read2_b32 v[108:109], v42 offset0:8 offset1:9
    v_mov_b64 v[110:111], v[114:115]
    v_add_u32 v42, 16, v42
    s_mov_b32 s14, 6
    s_waitcnt vmcnt(4)
    v_pk_fma_f32 v[22:23], v[22:23], v[44:45], 1.0 op_sel_hi:[1,1,0]
    v_pk_fma_f32 v[24:25], v[24:25], v[46:47], 1.0 op_sel_hi:[1,1,0]
    v_lshlrev_b64 v[44:45], 16, v[44:45]
    v_lshlrev_b64 v[46:47], 16, v[46:47]
    v_pk_fma_f32 v[30:31], v[30:31], v[52:53], 1.0 op_sel_hi:[1,1,0]
    v_pk_fma_f32 v[32:33], v[32:33], v[54:55], 1.0 op_sel_hi:[1,1,0]
    v_lshlrev_b64 v[52:53], 16, v[52:53]
    v_lshlrev_b64 v[54:55], 16, v[54:55]
    v_pk_fma_f32 v[18:19], v[18:19], v[44:45], 1.0 op_sel_hi:[1,1,0]
    v_pk_fma_f32 v[20:21], v[20:21], v[46:47], 1.0 op_sel_hi:[1,1,0]
    v_lshlrev_b64 v[44:45], 16, v[48:49]
    v_lshlrev_b64 v[46:47], 16, v[50:51]
    v_pk_fma_f32 v[26:27], v[26:27], v[52:53], 1.0 op_sel_hi:[1,1,0]
    v_pk_fma_f32 v[28:29], v[28:29], v[54:55], 1.0 op_sel_hi:[1,1,0]
    v_lshlrev_b64 v[52:53], 16, v[56:57]
    v_lshlrev_b64 v[54:55], 16, v[58:59]
    v_pk_mul_f32 v[48:49], v[48:49], v[30:31]
    v_pk_mul_f32 v[50:51], v[50:51], v[32:33]
    v_pk_mul_f32 v[44:45], v[44:45], v[26:27]
    v_pk_mul_f32 v[46:47], v[46:47], v[28:29]
    v_pk_fma_f32 v[48:49], v[56:57], v[22:23], v[48:49]
    v_pk_fma_f32 v[50:51], v[58:59], v[24:25], v[50:51]
    v_pk_fma_f32 v[44:45], v[52:53], v[18:19], v[44:45]
    v_pk_fma_f32 v[46:47], v[54:55], v[20:21], v[46:47]
    v_pk_mul_f32 v[56:57], v[22:23], v[30:31]
    v_pk_mul_f32 v[58:59], v[24:25], v[32:33]
    v_pk_mul_f32 v[52:53], v[18:19], v[26:27]
    v_pk_mul_f32 v[54:55], v[20:21], v[28:29]
    v_pk_add_f32 v[22:23], v[22:23], v[30:31]
    v_pk_add_f32 v[24:25], v[24:25], v[32:33]
    v_pk_add_f32 v[18:19], v[18:19], v[26:27]
    v_pk_add_f32 v[20:21], v[20:21], v[28:29]
    v_rcp_f32 v56, v56
    v_rcp_f32 v57, v57
    v_rcp_f32 v58, v58
    v_rcp_f32 v59, v59
    v_rcp_f32 v52, v52
    v_rcp_f32 v53, v53
    v_rcp_f32 v54, v54
    v_rcp_f32 v55, v55
    v_pk_mul_f32 v[30:31], v[48:49], v[56:57]
    v_pk_mul_f32 v[32:33], v[50:51], v[58:59]
    v_pk_mul_f32 v[26:27], v[44:45], v[52:53]
    v_pk_mul_f32 v[28:29], v[46:47], v[54:55]
    v_pk_fma_f32 v[22:23], v[22:23], v[56:57], s[28:29]
    v_pk_fma_f32 v[24:25], v[24:25], v[58:59], s[28:29]
    v_pk_fma_f32 v[18:19], v[18:19], v[52:53], s[28:29]
    v_pk_fma_f32 v[20:21], v[20:21], v[54:55], s[28:29]
    v_mad_u32_u16 v2, v112, s10, v8
    v_mad_u32_u16 v3, v113, s10, v8
    buffer_load_dwordx4 v[44:47], v2, s[48:51], 0 offen
    buffer_load_dwordx4 v[48:51], v2, s[48:51], 0 offen offset:64
    buffer_load_dwordx4 v[52:55], v3, s[48:51], 0 offen
    buffer_load_dwordx4 v[56:59], v3, s[48:51], 0 offen offset:64
    s_waitcnt vmcnt(4)
    v_pk_fma_f32 v[96:97], v[96:97], v[60:61], 1.0 op_sel_hi:[1,1,0]
    v_pk_fma_f32 v[98:99], v[98:99], v[62:63], 1.0 op_sel_hi:[1,1,0]
    v_lshlrev_b64 v[60:61], 16, v[60:61]
    v_lshlrev_b64 v[62:63], 16, v[62:63]
    v_pk_fma_f32 v[104:105], v[104:105], v[68:69], 1.0 op_sel_hi:[1,1,0]
    v_pk_fma_f32 v[106:107], v[106:107], v[70:71], 1.0 op_sel_hi:[1,1,0]
    v_lshlrev_b64 v[68:69], 16, v[68:69]
    v_lshlrev_b64 v[70:71], 16, v[70:71]
    v_pk_fma_f32 v[92:93], v[92:93], v[60:61], 1.0 op_sel_hi:[1,1,0]
    v_pk_fma_f32 v[94:95], v[94:95], v[62:63], 1.0 op_sel_hi:[1,1,0]
    v_lshlrev_b64 v[60:61], 16, v[64:65]
    v_lshlrev_b64 v[62:63], 16, v[66:67]
    v_pk_fma_f32 v[100:101], v[100:101], v[68:69], 1.0 op_sel_hi:[1,1,0]
    v_pk_fma_f32 v[102:103], v[102:103], v[70:71], 1.0 op_sel_hi:[1,1,0]
    v_lshlrev_b64 v[68:69], 16, v[72:73]
    v_lshlrev_b64 v[70:71], 16, v[74:75]
    v_pk_mul_f32 v[64:65], v[64:65], v[104:105]
    v_pk_mul_f32 v[66:67], v[66:67], v[106:107]
    v_pk_mul_f32 v[60:61], v[60:61], v[100:101]
    v_pk_mul_f32 v[62:63], v[62:63], v[102:103]
    v_pk_fma_f32 v[64:65], v[72:73], v[96:97], v[64:65]
    v_pk_fma_f32 v[66:67], v[74:75], v[98:99], v[66:67]
    v_pk_fma_f32 v[60:61], v[68:69], v[92:93], v[60:61]
    v_pk_fma_f32 v[62:63], v[70:71], v[94:95], v[62:63]
    v_pk_mul_f32 v[72:73], v[96:97], v[104:105]
    v_pk_mul_f32 v[74:75], v[98:99], v[106:107]
    v_pk_mul_f32 v[68:69], v[92:93], v[100:101]
    v_pk_mul_f32 v[70:71], v[94:95], v[102:103]
    v_pk_add_f32 v[96:97], v[96:97], v[104:105]
    v_pk_add_f32 v[98:99], v[98:99], v[106:107]
    v_pk_add_f32 v[92:93], v[92:93], v[100:101]
    v_pk_add_f32 v[94:95], v[94:95], v[102:103]
    v_rcp_f32 v72, v72
    v_rcp_f32 v73, v73
    v_rcp_f32 v74, v74
    v_rcp_f32 v75, v75
    v_rcp_f32 v68, v68
    v_rcp_f32 v69, v69
    v_rcp_f32 v70, v70
    v_rcp_f32 v71, v71
    v_pk_fma_f32 v[30:31], v[64:65], v[72:73], v[30:31]
    v_pk_fma_f32 v[32:33], v[66:67], v[74:75], v[32:33]
    v_pk_fma_f32 v[26:27], v[60:61], v[68:69], v[26:27]
    v_pk_fma_f32 v[28:29], v[62:63], v[70:71], v[28:29]
    v_pk_fma_f32 v[22:23], v[96:97], v[72:73], v[22:23]
    v_pk_fma_f32 v[24:25], v[98:99], v[74:75], v[24:25]
    v_pk_fma_f32 v[18:19], v[92:93], v[68:69], v[18:19]
    v_pk_fma_f32 v[20:21], v[94:95], v[70:71], v[20:21]
    v_mad_u32_u16 v2, v110, s10, v8
    v_mad_u32_u16 v3, v111, s10, v8
    buffer_load_dwordx4 v[60:63], v2, s[48:51], 0 offen
    buffer_load_dwordx4 v[64:67], v2, s[48:51], 0 offen offset:64
    buffer_load_dwordx4 v[68:71], v3, s[48:51], 0 offen
    buffer_load_dwordx4 v[72:75], v3, s[48:51], 0 offen offset:64
    s_waitcnt vmcnt(4)
    v_pk_fma_f32 v[80:81], v[80:81], v[44:45], 1.0 op_sel_hi:[1,1,0]
    v_pk_fma_f32 v[82:83], v[82:83], v[46:47], 1.0 op_sel_hi:[1,1,0]
    v_lshlrev_b64 v[44:45], 16, v[44:45]
    v_lshlrev_b64 v[46:47], 16, v[46:47]
    v_pk_fma_f32 v[88:89], v[88:89], v[52:53], 1.0 op_sel_hi:[1,1,0]
    v_pk_fma_f32 v[90:91], v[90:91], v[54:55], 1.0 op_sel_hi:[1,1,0]
    v_lshlrev_b64 v[52:53], 16, v[52:53]
    v_lshlrev_b64 v[54:55], 16, v[54:55]
    v_pk_fma_f32 v[76:77], v[76:77], v[44:45], 1.0 op_sel_hi:[1,1,0]
    v_pk_fma_f32 v[78:79], v[78:79], v[46:47], 1.0 op_sel_hi:[1,1,0]
    v_lshlrev_b64 v[44:45], 16, v[48:49]
    v_lshlrev_b64 v[46:47], 16, v[50:51]
    v_pk_fma_f32 v[84:85], v[84:85], v[52:53], 1.0 op_sel_hi:[1,1,0]
    v_pk_fma_f32 v[86:87], v[86:87], v[54:55], 1.0 op_sel_hi:[1,1,0]
    v_lshlrev_b64 v[52:53], 16, v[56:57]
    v_lshlrev_b64 v[54:55], 16, v[58:59]
    v_pk_mul_f32 v[48:49], v[48:49], v[88:89]
    v_pk_mul_f32 v[50:51], v[50:51], v[90:91]
    v_pk_mul_f32 v[44:45], v[44:45], v[84:85]
    v_pk_mul_f32 v[46:47], v[46:47], v[86:87]
    v_pk_fma_f32 v[48:49], v[56:57], v[80:81], v[48:49]
    v_pk_fma_f32 v[50:51], v[58:59], v[82:83], v[50:51]
    v_pk_fma_f32 v[44:45], v[52:53], v[76:77], v[44:45]
    v_pk_fma_f32 v[46:47], v[54:55], v[78:79], v[46:47]
    v_pk_mul_f32 v[56:57], v[80:81], v[88:89]
    v_pk_mul_f32 v[58:59], v[82:83], v[90:91]
    v_pk_mul_f32 v[52:53], v[76:77], v[84:85]
    v_pk_mul_f32 v[54:55], v[78:79], v[86:87]
    v_pk_add_f32 v[80:81], v[80:81], v[88:89]
    v_pk_add_f32 v[82:83], v[82:83], v[90:91]
    v_pk_add_f32 v[76:77], v[76:77], v[84:85]
    v_pk_add_f32 v[78:79], v[78:79], v[86:87]
    v_rcp_f32 v56, v56
    v_rcp_f32 v57, v57
    v_rcp_f32 v58, v58
    v_rcp_f32 v59, v59
    v_rcp_f32 v52, v52
    v_rcp_f32 v53, v53
    v_rcp_f32 v54, v54
    v_rcp_f32 v55, v55
    v_pk_fma_f32 v[30:31], v[48:49], v[56:57], v[30:31]
    v_pk_fma_f32 v[32:33], v[50:51], v[58:59], v[32:33]
    v_pk_fma_f32 v[26:27], v[44:45], v[52:53], v[26:27]
    v_pk_fma_f32 v[28:29], v[46:47], v[54:55], v[28:29]
    v_pk_fma_f32 v[22:23], v[80:81], v[56:57], v[22:23]
    v_pk_fma_f32 v[24:25], v[82:83], v[58:59], v[24:25]
    v_pk_fma_f32 v[18:19], v[76:77], v[52:53], v[18:19]
    v_pk_fma_f32 v[20:21], v[78:79], v[54:55], v[20:21]
    s_branch K_TOP1
K_NOTFAST:
    s_mov_b32 s12, 1
    s_cmp_lg_u32 s6, 2
    s_cbranch_scc1 K_SLOW
    s_mov_b32 s12, 0
    s_mov_b32 s25, 1
    s_mov_b32 s8, 0xdc68e091
    s_mov_b32 s9, 0x4b5af723
    s_lshl_b32 s6, s3, 2
    s_lshr_b64 s[8:9], s[8:9], s6
    s_and_b32 s6, s8, 15
    s_lshl_b32 s6, s6, 6
    v_add_u32 v4, s6, v0
    ds_read_b32 v4, v4
    s_branch K_GRP1
K_PRI0:
    ds_read_b32 v112, v9 offset:0
    s_sub_u32 s7, s15, s14
    s_waitcnt lgkmcnt(0)
    v_readfirstlane_b32 s6, v112
    s_cmp_lt_u32 s6, 9
    s_cbranch_scc1 K_PRB0
    s_setprio 1
    s_cmp_gt_u32 s7, 2
    s_cbranch_scc1 K_PRB0
    s_setprio 0
    s_branch K_PRB0
K_NOG0:
    s_cmp_lg_u32 s25, 0
    s_cbranch_scc1 K_SNOG0
    v_pk_fma_f32 v[76:77], v[116:117], v[10:11], v[34:35] op_sel_hi:[0,1,1]
    v_pk_fma_f32 v[78:79], v[116:117], v[12:13], v[36:37] op_sel_hi:[0,1,1]
    v_pk_fma_f32 v[80:81], v[116:117], v[14:15], v[38:39] op_sel_hi:[0,1,1]
    v_pk_fma_f32 v[82:83], v[116:117], v[16:17], v[40:41] op_sel_hi:[0,1,1]
    v_exp_f32 v76, v76
    v_exp_f32 v77, v77
    v_exp_f32 v78, v78
    v_exp_f32 v79, v79
    v_exp_f32 v80, v80
    v_exp_f32 v81, v81
    v_exp_f32 v82, v82
    v_exp_f32 v83, v83
    s_add_u32 s6, s14, 1
    s_cmp_ge_u32 s6, s15
    s_cbranch_scc1 K_NOGB0
    v_pk_fma_f32 v[84:85], v[116:117], v[10:11], v[34:35] op_sel:[1,0,0] op_sel_hi:[1,1,1]
    v_pk_fma_f32 v[86:87], v[116:117], v[12:13], v[36:37] op_sel:[1,0,0] op_sel_hi:[1,1,1]
    v_pk_fma_f32 v[88:89], v[116:117], v[14:15], v[38:39] op_sel:[1,0,0] op_sel_hi:[1,1,1]
    v_pk_fma_f32 v[90:91], v[116:117], v[16:17], v[40:41] op_sel:[1,0,0] op_sel_hi:[1,1,1]
    v_exp_f32 v84, v84
    v_exp_f32 v85, v85
    v_exp_f32 v86, v86
    v_exp_f32 v87, v87
    v_exp_f32 v88, v88
    v_exp_f32 v89, v89
    v_exp_f32 v90, v90
    v_exp_f32 v91, v91
K_NOGB0:
    s_waitcnt vmcnt(0)
    s_branch K_GOT0
K_TAIL0:
    v_cmpx_lt_u32 vcc, s14, v5
    s_cmp_lg_u32 s25, 0
    s_cbranch_scc1 K_STAIL0
    v_pk_fma_f32 v[80:81], v[80:81], v[44:45], 1.0 op_sel_hi:[1,1,0]
    v_pk_fma_f32 v[82:83], v[82:83], v[46:47], 1.0 op_sel_hi:[1,1,0]
    v_lshlrev_b64 v[44:45], 16, v[44:45]
    v_lshlrev_b64 v[46:47], 16, v[46:47]
    v_pk_fma_f32 v[76:77], v[76:77], v[44:45], 1.0 op_sel_hi:[1,1,0]
    v_pk_fma_f32 v[78:79], v[78:79], v[46:47], 1.0 op_sel_hi:[1,1,0]
    v_lshlrev_b64 v[44:45], 16, v[48:49]
    v_lshlrev_b64 v[46:47], 16, v[50:51]
    v_rcp_f32 v80, v80
    v_rcp_f32 v81, v81
    v_rcp_f32 v82, v82
    v_rcp_f32 v83, v83
    v_rcp_f32 v76, v76
    v_rcp_f32 v77, v77
    v_rcp_f32 v78, v78
    v_rcp_f32 v79, v79
    v_pk_add_f32 v[22:23], v[22:23], v[80:81]
    v_pk_add_f32 v[24:25], v[24:25], v[82:83]
    v_pk_add_f32 v[18:19], v[18:19], v[76:77]
    v_pk_add_f32 v[20:21], v[20:21], v[78:79]
    v_pk_fma_f32 v[30:31], v[48:49], v[80:81], v[30:31]
    v_pk_fma_f32 v[32:33], v[50:51], v[82:83], v[32:33]
    v_pk_fma_f32 v[26:27], v[44:45], v[76:77], v[26:27]
    v_pk_fma_f32 v[28:29], v[46:47], v[78:79], v[28:29]
    s_add_u32 s6, s14, 1
    s_cmp_ge_u32 s6, s15
    s_cbranch_scc1 K_EPI
    v_cmpx_lt_u32 vcc, s6, v5
    v_pk_fma_f32 v[88:89], v[88:89], v[52:53], 1.0 op_sel_hi:[1,1,0]
    v_pk_fma_f32 v[90:91], v[90:91], v[54:55], 1.0 op_sel_hi:[1,1,0]
    v_lshlrev_b64 v[52:53], 16, v[52:53]
    v_lshlrev_b64 v[54:55], 16, v[54:55]
    v_pk_fma_f32 v[84:85], v[84:85], v[52:53], 1.0 op_sel_hi:[1,1,0]
    v_pk_fma_f32 v[86:87], v[86:87], v[54:55], 1.0 op_sel_hi:[1,1,0]
    v_lshlrev_b64 v[52:53], 16, v[56:57]
    v_lshlrev_b64 v[54:55], 16, v[58:59]
    v_rcp_f32 v88, v88
    v_rcp_f32 v89, v89
    v_rcp_f32 v90, v90
    v_rcp_f32 v91, v91
    v_rcp_f32 v84, v84
    v_rcp_f32 v85, v85
    v_rcp_f32 v86, v86
    v_rcp_f32 v87, v87
    v_pk_add_f32 v[22:23], v[22:23], v[88:89]
    v_pk_add_f32 v[24:25], v[24:25], v[90:91]
    v_pk_add_f32 v[18:19], v[18:19], v[84:85]
    v_pk_add_f32 v[20:21], v[20:21], v[86:87]
    v_pk_fma_f32 v[30:31], v[56:57], v[88:89], v[30:31]
    v_pk_fma_f32 v[32:33], v[58:59], v[90:91], v[32:33]
    v_pk_fma_f32 v[26:27], v[52:53], v[84:85], v[26:27]
    v_pk_fma_f32 v[28:29], v[54:55], v[86:87], v[28:29]
    s_branch K_NEXT0
K_PRI1:
    ds_read_b32 v112, v9 offset:0
    s_sub_u32 s7, s15, s14
    s_waitcnt lgkmcnt(0)
    v_readfirstlane_b32 s6, v112
    s_cmp_lt_u32 s6, 9
    s_cbranch_scc1 K_PRB1
    s_setprio 1
    s_cmp_gt_u32 s7, 2
    s_cbranch_scc1 K_PRB1
    s_setprio 0
    s_branch K_PRB1
K_NOG1:
    s_cmp_lg_u32 s25, 0
    s_cbranch_scc1 K_SNOG1
    v_pk_fma_f32 v[76:77], v[118:119], v[10:11], v[34:35] op_sel_hi:[0,1,1]
    v_pk_fma_f32 v[78:79], v[118:119], v[12:13], v[36:37] op_sel_hi:[0,1,1]
    v_pk_fma_f32 v[80:81], v[118:119], v[14:15], v[38:39] op_sel_hi:[0,1,1]
    v_pk_fma_f32 v[82:83], v[118:119], v[16:17], v[40:41] op_sel_hi:[0,1,1]
    v_exp_f32 v76, v76
    v_exp_f32 v77, v77
    v_exp_f32 v78, v78
    v_exp_f32 v79, v79
    v_exp_f32 v80, v80
    v_exp_f32 v81, v81
    v_exp_f32 v82, v82
    v_exp_f32 v83, v83
    s_add_u32 s6, s14, 1
    s_cmp_ge_u32 s6, s15
    s_cbranch_scc1 K_NOGB1
    v_pk_fma_f32 v[84:85], v[118:119], v[10:11], v[34:35] op_sel:[1,0,0] op_sel_hi:[1,1,1]
    v_pk_fma_f32 v[86:87], v[118:119], v[12:13], v[36:37] op_sel:[1,0,0] op_sel_hi:[1,1,1]
    v_pk_fma_f32 v[88:89], v[118:119], v[14:15], v[38:39] op_sel:[1,0,0] op_sel_hi:[1,1,1]
    v_pk_fma_f32 v[90:91], v[118:119], v[16:17], v[40:41] op_sel:[1,0,0] op_sel_hi:[1,1,1]
    v_exp_f32 v84, v84
    v_exp_f32 v85, v85
    v_exp_f32 v86, v86
    v_exp_f32 v87, v87
    v_exp_f32 v88, v88
    v_exp_f32 v89, v89
    v_exp_f32 v90, v90
    v_exp_f32 v91, v91
K_NOGB1:
    s_waitcnt vmcnt(0)
    s_branch K_GOT1
K_TAIL1:
    v_cmpx_lt_u32 vcc, s14, v5
    s_cmp_lg_u32 s25, 0
    s_cbranch_scc1 K_STAIL1
    v_pk_fma_f32 v[80:81], v[80:81], v[60:61], 1.0 op_sel_hi:[1,1,0]
    v_pk_fma_f32 v[82:83], v[82:83], v[62:63], 1.0 op_sel_hi:[1,1,0]
    v_lshlrev_b64 v[60:61], 16, v[60:61]
    v_lshlrev_b64 v[62:63], 16, v[62:63]
    v_pk_fma_f32 v[76:77], v[76:77], v[60:61], 1.0 op_sel_hi:[1,1,0]
    v_pk_fma_f32 v[78:79], v[78:79], v[62:63], 1.0 op_sel_hi:[1,1,0]
    v_lshlrev_b64 v[60:61], 16, v[64:65]
    v_lshlrev_b64 v[62:63], 16, v[66:67]
    v_rcp_f32 v80, v80
    v_rcp_f32 v81, v81
    v_rcp_f32 v82, v82
    v_rcp_f32 v83, v83
    v_rcp_f32 v76, v76
    v_rcp_f32 v77, v77
    v_rcp_f32 v78, v78
    v_rcp_f32 v79, v79
    v_pk_add_f32 v[22:23], v[22:23], v[80:81]
    v_pk_add_f32 v[24:25], v[24:25], v[82:83]
    v_pk_add_f32 v[18:19], v[18:19], v[76:77]
    v_pk_add_f32 v[20:21], v[20:21], v[78:79]
    v_pk_fma_f32 v[30:31], v[64:65], v[80:81], v[30:31]
    v_pk_fma_f32 v[32:33], v[66:67], v[82:83], v[32:33]
    v_pk_fma_f32 v[26:27], v[60:61], v[76:77], v[26:27]
    v_pk_fma_f32 v[28:29], v[62:63], v[78:79], v[28:29]
    s_add_u32 s6, s14, 1
    s_cmp_ge_u32 s6, s15
    s_cbranch_scc1 K_EPI
    v_cmpx_lt_u32 vcc, s6, v5
    v_pk_fma_f32 v[88:89], v[88:89], v[68:69], 1.0 op_sel_hi:[1,1,0]
    v_pk_fma_f32 v[90:91], v[90:91], v[70:71], 1.0 op_sel_hi:[1,1,0]
    v_lshlrev_b64 v[68:69], 16, v[68:69]
    v_lshlrev_b64 v[70:71], 16, v[70:71]
    v_pk_fma_f32 v[84:85], v[84:85], v[68:69], 1.0 op_sel_hi:[1,1,0]
    v_pk_fma_f32 v[86:87], v[86:87], v[70:71], 1.0 op_sel_hi:[1,1,0]
    v_lshlrev_b64 v[68:69], 16, v[72:73]
    v_lshlrev_b64 v[70:71], 16, v[74:75]
    v_rcp_f32 v88, v88
    v_rcp_f32 v89, v89
    v_rcp_f32 v90, v90
    v_rcp_f32 v91, v91
    v_rcp_f32 v84, v84
    v_rcp_f32 v85, v85
    v_rcp_f32 v86, v86
    v_rcp_f32 v87, v87
    v_pk_add_f32 v[22:23], v[22:23], v[88:89]
    v_pk_add_f32 v[24:25], v[24:25], v[90:91]
    v_pk_add_f32 v[18:19], v[18:19], v[84:85]
    v_pk_add_f32 v[20:21], v[20:21], v[86:87]
    v_pk_fma_f32 v[30:31], v[72:73], v[88:89], v[30:31]
    v_pk_fma_f32 v[32:33], v[74:75], v[90:91], v[32:33]
    v_pk_fma_f32 v[26:27], v[68:69], v[84:85], v[26:27]
    v_pk_fma_f32 v[28:29], v[70:71], v[86:87], v[28:29]
    s_branch K_NEXT1
K_SNOG0:
    v_pk_fma_f32 v[76:77], v[116:117], v[10:11], v[34:35] op_sel_hi:[0,1,1]
    v_pk_fma_f32 v[78:79], v[116:117], v[12:13], v[36:37] op_sel_hi:[0,1,1]
    v_pk_fma_f32 v[80:81], v[116:117], v[14:15], v[38:39] op_sel_hi:[0,1,1]
    v_pk_fma_f32 v[82:83], v[116:117], v[16:17], v[40:41] op_sel_hi:[0,1,1]
    v_pk_fma_f32 v[84:85], v[116:117], v[10:11], v[34:35] op_sel:[1,0,0] op_sel_hi:[1,1,1]
    v_pk_fma_f32 v[86:87], v[116:117], v[12:13], v[36:37] op_sel:[1,0,0] op_sel_hi:[1,1,1]
    v_pk_fma_f32 v[88:89], v[116:117], v[14:15], v[38:39] op_sel:[1,0,0] op_sel_hi:[1,1,1]
    v_pk_fma_f32 v[90:91], v[116:117], v[16:17], v[40:41] op_sel:[1,0,0] op_sel_hi:[1,1,1]
    s_branch K_NOGB0
K_STAIL0:
    v_lshlrev_b64 v[92:93], 16, v[44:45]
    v_lshlrev_b64 v[94:95], 16, v[46:47]
    v_log_f32 v44, v44
    v_log_f32 v45, v45
    v_log_f32 v46, v46
    v_log_f32 v47, v47
    v_log_f32 v92, v92
    v_log_f32 v93, v93
    v_log_f32 v94, v94
    v_log_f32 v95, v95
    v_pk_add_f32 v[80:81], v[80:81], v[44:45]
    v_pk_add_f32 v[82:83], v[82:83], v[46:47]
    v_pk_add_f32 v[76:77], v[76:77], v[92:93]
    v_pk_add_f32 v[78:79], v[78:79], v[94:95]
    v_exp_f32 v80, v80
    v_exp_f32 v81, v81
    v_exp_f32 v82, v82
    v_exp_f32 v83, v83
    v_exp_f32 v76, v76
    v_exp_f32 v77, v77
    v_exp_f32 v78, v78
    v_exp_f32 v79, v79
    v_lshlrev_b64 v[44:45], 16, v[48:49]
    v_lshlrev_b64 v[46:47], 16, v[50:51]
    v_pk_add_f32 v[80:81], v[80:81], 1.0 op_sel_hi:[1,0]
    v_pk_add_f32 v[82:83], v[82:83], 1.0 op_sel_hi:[1,0]
    v_pk_add_f32 v[76:77], v[76:77], 1.0 op_sel_hi:[1,0]
    v_pk_add_f32 v[78:79], v[78:79], 1.0 op_sel_hi:[1,0]
    v_rcp_f32 v80, v80
    v_rcp_f32 v81, v81
    v_rcp_f32 v82, v82
    v_rcp_f32 v83, v83
    v_rcp_f32 v76, v76
    v_rcp_f32 v77, v77
    v_rcp_f32 v78, v78
    v_rcp_f32 v79, v79
    v_pk_add_f32 v[22:23], v[22:23], v[80:81]
    v_pk_add_f32 v[24:25], v[24:25], v[82:83]
    v_pk_add_f32 v[18:19], v[18:19], v[76:77]
    v_pk_add_f32 v[20:21], v[20:21], v[78:79]
    v_pk_fma_f32 v[30:31], v[48:49], v[80:81], v[30:31]
    v_pk_fma_f32 v[32:33], v[50:51], v[82:83], v[32:33]
    v_pk_fma_f32 v[26:27], v[44:45], v[76:77], v[26:27]
    v_pk_fma_f32 v[28:29], v[46:47], v[78:79], v[28:29]
    s_add_u32 s6, s14, 1
    s_cmp_ge_u32 s6, s15
    s_cbranch_scc1 K_EPI
    v_cmpx_lt_u32 vcc, s6, v5
    v_lshlrev_b64 v[92:93], 16, v[52:53]
    v_lshlrev_b64 v[94:95], 16, v[54:55]
    v_log_f32 v52, v52
    v_log_f32 v53, v53
    v_log_f32 v54, v54
    v_log_f32 v55, v55
    v_log_f32 v92, v92
    v_log_f32 v93, v93
    v_log_f32 v94, v94
    v_log_f32 v95, v95
    v_pk_add_f32 v[88:89], v[88:89], v[52:53]
    v_pk_add_f32 v[90:91], v[90:91], v[54:55]
    v_pk_add_f32 v[84:85], v[84:85], v[92:93]
    v_pk_add_f32 v[86:87], v[86:87], v[94:95]
    v_exp_f32 v88, v88
    v_exp_f32 v89, v89
    v_exp_f32 v90, v90
    v_exp_f32 v91, v91
    v_exp_f32 v84, v84
    v_exp_f32 v85, v85
    v_exp_f32 v86, v86
    v_exp_f32 v87, v87
    v_lshlrev_b64 v[52:53], 16, v[56:57]
    v_lshlrev_b64 v[54:55], 16, v[58:59]
    v_pk_add_f32 v[88:89], v[88:89], 1.0 op_sel_hi:[1,0]
    v_pk_add_f32 v[90:91], v[90:91], 1.0 op_sel_hi:[1,0]
    v_pk_add_f32 v[84:85], v[84:85], 1.0 op_sel_hi:[1,0]
    v_pk_add_f32 v[86:87], v[86:87], 1.0 op_sel_hi:[1,0]
    v_rcp_f32 v88, v88
    v_rcp_f32 v89, v89
    v_rcp_f32 v90, v90
    v_rcp_f32 v91, v91
    v_rcp_f32 v84, v84
    v_rcp_f32 v85, v85
    v_rcp_f32 v86, v86
    v_rcp_f32 v87, v87
    v_pk_add_f32 v[22:23], v[22:23], v[88:89]
    v_pk_add_f32 v[24:25], v[24:25], v[90:91]
    v_pk_add_f32 v[18:19], v[18:19], v[84:85]
    v_pk_add_f32 v[20:21], v[20:21], v[86:87]
    v_pk_fma_f32 v[30:31], v[56:57], v[88:89], v[30:31]
    v_pk_fma_f32 v[32:33], v[58:59], v[90:91], v[32:33]
    v_pk_fma_f32 v[26:27], v[52:53], v[84:85], v[26:27]
    v_pk_fma_f32 v[28:29], v[54:55], v[86:87], v[28:29]
    s_branch K_NEXT0
K_SNOG1:
    v_pk_fma_f32 v[76:77], v[118:119], v[10:11], v[34:35] op_sel_hi:[0,1,1]
    v_pk_fma_f32 v[78:79], v[118:119], v[12:13], v[36:37] op_sel_hi:[0,1,1]
    v_pk_fma_f32 v[80:81], v[118:119], v[14:15], v[38:39] op_sel_hi:[0,1,1]
    v_pk_fma_f32 v[82:83], v[118:119], v[16:17], v[40:41] op_sel_hi:[0,1,1]
    v_pk_fma_f32 v[84:85], v[118:119], v[10:11], v[34:35] op_sel:[1,0,0] op_sel_hi:[1,1,1]
    v_pk_fma_f32 v[86:87], v[118:119], v[12:13], v[36:37] op_sel:[1,0,0] op_sel_hi:[1,1,1]
    v_pk_fma_f32 v[88:89], v[118:119], v[14:15], v[38:39] op_sel:[1,0,0] op_sel_hi:[1,1,1]
    v_pk_fma_f32 v[90:91], v[118:119], v[16:17], v[40:41] op_sel:[1,0,0] op_sel_hi:[1,1,1]
    s_branch K_NOGB1
K_STAIL1:
    v_lshlrev_b64 v[92:93], 16, v[60:61]
    v_lshlrev_b64 v[94:95], 16, v[62:63]
    v_log_f32 v60, v60
    v_log_f32 v61, v61
    v_log_f32 v62, v62
    v_log_f32 v63, v63
    v_log_f32 v92, v92
    v_log_f32 v93, v93
    v_log_f32 v94, v94
    v_log_f32 v95, v95
    v_pk_add_f32 v[80:81], v[80:81], v[60:61]
    v_pk_add_f32 v[82:83], v[82:83], v[62:63]
    v_pk_add_f32 v[76:77], v[76:77], v[92:93]
    v_pk_add_f32 v[78:79], v[78:79], v[94:95]
    v_exp_f32 v80, v80
    v_exp_f32 v81, v81
    v_exp_f32 v82, v82
    v_exp_f32 v83, v83
    v_exp_f32 v76, v76
    v_exp_f32 v77, v77
    v_exp_f32 v78, v78
    v_exp_f32 v79, v79
    v_lshlrev_b64 v[60:61], 16, v[64:65]
    v_lshlrev_b64 v[62:63], 16, v[66:67]
    v_pk_add_f32 v[80:81], v[80:81], 1.0 op_sel_hi:[1,0]
    v_pk_add_f32 v[82:83], v[82:83], 1.0 op_sel_hi:[1,0]
    v_pk_add_f32 v[76:77], v[76:77], 1.0 op_sel_hi:[1,0]
    v_pk_add_f32 v[78:79], v[78:79], 1.0 op_sel_hi:[1,0]
    v_rcp_f32 v80, v80
    v_rcp_f32 v81, v81
    v_rcp_f32 v82, v82
    v_rcp_f32 v83, v83
    v_rcp_f32 v76, v76
    v_rcp_f32 v77, v77
    v_rcp_f32 v78, v78
    v_rcp_f32 v79, v79
    v_pk_add_f32 v[22:23], v[22:23], v[80:81]
    v_pk_add_f32 v[24:25], v[24:25], v[82:83]
    v_pk_add_f32 v[18:19], v[18:19], v[76:77]
    v_pk_add_f32 v[20:21], v[20:21], v[78:79]
    v_pk_fma_f32 v[30:31], v[64:65], v[80:81], v[30:31]
    v_pk_fma_f32 v[32:33], v[66:67], v[82:83], v[32:33]
    v_pk_fma_f32 v[26:27], v[60:61], v[76:77], v[26:27]
    v_pk_fma_f32 v[28:29], v[62:63], v[78:79], v[28:29]
    s_add_u32 s6, s14, 1
    s_cmp_ge_u32 s6, s15
    s_cbranch_scc1 K_EPI
    v_cmpx_lt_u32 vcc, s6, v5
    v_lshlrev_b64 v[92:93], 16, v[68:69]
    v_lshlrev_b64 v[94:95], 16, v[70:71]
    v_log_f32 v68, v68
    v_log_f32 v69, v69
    v_log_f32 v70, v70
    v_log_f32 v71, v71
    v_log_f32 v92, v92
    v_log_f32 v93, v93
    v_log_f32 v94, v94
    v_log_f32 v95, v95
    v_pk_add_f32 v[88:89], v[88:89], v[68:69]
    v_pk_add_f32 v[90:91], v[90:91], v[70:71]
    v_pk_add_f32 v[84:85], v[84:85], v[92:93]
    v_pk_add_f32 v[86:87], v[86:87], v[94:95]
    v_exp_f32 v88, v88
    v_exp_f32 v89, v89
    v_exp_f32 v90, v90
    v_exp_f32 v91, v91
    v_exp_f32 v84, v84
    v_exp_f32 v85, v85
    v_exp_f32 v86, v86
    v_exp_f32 v87, v87
    v_lshlrev_b64 v[68:69], 16, v[72:73]
    v_lshlrev_b64 v[70:71], 16, v[74:75]
    v_pk_add_f32 v[88:89], v[88:89], 1.0 op_sel_hi:[1,0]
    v_pk_add_f32 v[90:91], v[90:91], 1.0 op_sel_hi:[1,0]
    v_pk_add_f32 v[84:85], v[84:85], 1.0 op_sel_hi:[1,0]
    v_pk_add_f32 v[86:87], v[86:87], 1.0 op_sel_hi:[1,0]
    v_rcp_f32 v88, v88
    v_rcp_f32 v89, v89
    v_rcp_f32 v90, v90
    v_rcp_f32 v91, v91
    v_rcp_f32 v84, v84
    v_rcp_f32 v85, v85
    v_rcp_f32 v86, v86
    v_rcp_f32 v87, v87
    v_pk_add_f32 v[22:23], v[22:23], v[88:89]
    v_pk_add_f32 v[24:25], v[24:25], v[90:91]
    v_pk_add_f32 v[18:19], v[18:19], v[84:85]
    v_pk_add_f32 v[20:21], v[20:21], v[86:87]
    v_pk_fma_f32 v[30:31], v[72:73], v[88:89], v[30:31]
    v_pk_fma_f32 v[32:33], v[74:75], v[90:91], v[32:33]
    v_pk_fma_f32 v[26:27], v[68:69], v[84:85], v[26:27]
    v_pk_fma_f32 v[28:29], v[70:71], v[86:87], v[28:29]
    s_branch K_NEXT1
K_SLOW:
    s_waitcnt lgkmcnt(0)
    s_mov_b32 s16, s3
    v_mbcnt_lo_u32_b32 v62, -1, 0
    v_mbcnt_hi_u32_b32 v62, -1, v62
    s_mov_b32 s1, 0x400000
SP_53:
    ds_read_b32 v4, v9 offset:60
    s_waitcnt lgkmcnt(0)
    v_readfirstlane_b32 s6, v4
    s_cmp_ge_u32 s6, 1
    s_cbranch_scc1 SPD_54
    s_sleep 1
    s_sub_u32 s1, s1, 1
    s_cbranch_scc0 SP_53
SPD_54:
    v_lshlrev_b32 v64, 2, v62
    v_add_u32 v64, 161760, v64
    ds_read_b32 v64, v64
K_SGRP:
    s_lshl_b32 s6, s16, 4
    v_lshrrev_b32 v42, 2, v62
    v_add_u32 v42, s6, v42
    v_mul_u32_u24 v2, 144, v42
    v_add_u32 v2, v2, v6
    ds_read_b128 v[34:37], v2
    ds_read_b128 v[120:123], v2 offset:64
    v_lshl_add_u32 v43, v42, 8, v1
    v_sub_u32 v4, 390, v42
    v_and_or_b32 v43, v4, s79, v43
    buffer_load_dwordx4 v[124:127], v43, s[40:43], s0 offen
    v_mov_b32 v18, 0x358637bd
    v_mov_b32 v26, 0
    v_mov_b32 v19, 0x358637bd
    v_mov_b32 v27, 0
    v_mov_b32 v20, 0x358637bd
    v_mov_b32 v28, 0
    v_mov_b32 v21, 0x358637bd
    v_mov_b32 v29, 0
    v_mov_b32 v22, 0x358637bd
    v_mov_b32 v30, 0
    v_mov_b32 v23, 0x358637bd
    v_mov_b32 v31, 0
    v_mov_b32 v24, 0x358637bd
    v_mov_b32 v32, 0
    v_mov_b32 v25, 0x358637bd
    v_mov_b32 v33, 0
    s_waitcnt lgkmcnt(0)
    v_and_b32 v38, s72, v34
    v_and_b32 v39, s72, v35
    v_and_b32 v40, s72, v36
    v_and_b32 v41, s72, v37
    v_lshlrev_b32 v34, 16, v34
    v_lshlrev_b32 v35, 16, v35
    v_lshlrev_b32 v36, 16, v36
    v_lshlrev_b32 v37, 16, v37
    s_mov_b32 s17, 0
K_SSEG:
    s_lshl_b32 s6, s17, 2
    s_add_u32 s6, s6, 162096
    v_mov_b32 v63, s6
    ds_read_b32 v63, v63
    s_waitcnt lgkmcnt(0)
    v_readfirstlane_b32 s19, v63
    s_lshr_b32 s18, s19, 16
    s_and_b32 s19, s19, 0xffff
K_SBLK:
    s_cmp_eq_u32 s18, 0
    s_cbranch_scc1 K_SSEGN
    s_lshl_b32 s6, s17, 13
    v_add_u32 v63, s19, v62
    v_lshlrev_b32 v2, 2, v63
    v_add_u32 v63, 6528, v63
    buffer_load_dword v60, v2, s[52:55], s6 offen
    buffer_load_ubyte v61, v63, s[52:55], s6 offen
    s_min_u32 s21, s18, 64
    s_sub_u32 s18, s18, s21
    s_add_u32 s19, s19, 64
    s_mov_b32 s20, 0
    s_waitcnt vmcnt(0)
    v_bfe_u32 v63, v60, 15, 1
    v_lshl_or_b32 v61, v61, 1, v63
    s_nop 0
K_SREC:
    v_readlane_b32 s23, v61, s20
    s_lshr_b32 s6, s23, 4
    s_cmp_lg_u32 s6, s16
    s_cbranch_scc1 K_SRECN
    v_readlane_b32 s22, v60, s20
    s_and_b32 s6, s22, 0x7fff
    s_mul_i32 s7, s6, 42909
    s_lshr_b32 s7, s7, 24
    s_mul_i32 s8, s7, 391
    s_sub_u32 s8, s6, s8
    s_lshr_b32 s8, s8, 5
    v_readlane_b32 s7, v64, s7
    s_lshl_b32 s6, s6, 7
    s_and_b32 s22, s22, s72
    v_add_u32 v2, s6, v8
    v_mov_b32 v108, s22
    v_cmpx_eq_u32 vcc, s23, v42
    buffer_load_dwordx4 v[44:47], v2, s[48:51], 0 offen
    buffer_load_dwordx4 v[48:51], v2, s[48:51], 0 offen offset:64
    s_waitcnt vmcnt(0)
    v_lshlrev_b64 v[92:93], 16, v[44:45]
    v_lshlrev_b64 v[94:95], 16, v[46:47]
    v_lshlrev_b64 v[96:97], 16, v[48:49]
    v_lshlrev_b64 v[98:99], 16, v[50:51]
    s_bitcmp1_b32 s7, s8
    s_cbranch_scc1 K_SRAW
    v_log_f32 v92, v92
    v_log_f32 v93, v93
    v_log_f32 v94, v94
    v_log_f32 v95, v95
    v_log_f32 v44, v44
    v_log_f32 v45, v45
    v_log_f32 v46, v46
    v_log_f32 v47, v47
K_SRAW:
    v_pk_add_f32 v[92:93], v[92:93], v[34:35]
    v_pk_add_f32 v[94:95], v[94:95], v[36:37]
    v_pk_add_f32 v[44:45], v[44:45], v[38:39]
    v_pk_add_f32 v[46:47], v[46:47], v[40:41]
    v_pk_fma_f32 v[92:93], v[108:109], v[10:11], v[92:93] op_sel_hi:[0,1,1]
    v_pk_fma_f32 v[94:95], v[108:109], v[12:13], v[94:95] op_sel_hi:[0,1,1]
    v_pk_fma_f32 v[44:45], v[108:109], v[14:15], v[44:45] op_sel_hi:[0,1,1]
    v_pk_fma_f32 v[46:47], v[108:109], v[16:17], v[46:47] op_sel_hi:[0,1,1]
    v_exp_f32 v92, v92
    v_exp_f32 v93, v93
    v_exp_f32 v94, v94
    v_exp_f32 v95, v95
    v_exp_f32 v44, v44
    v_exp_f32 v45, v45
    v_exp_f32 v46, v46
    v_exp_f32 v47, v47
    v_pk_add_f32 v[92:93], v[92:93], 1.0 op_sel_hi:[1,0]
    v_pk_add_f32 v[94:95], v[94:95], 1.0 op_sel_hi:[1,0]
    v_pk_add_f32 v[44:45], v[44:45], 1.0 op_sel_hi:[1,0]
    v_pk_add_f32 v[46:47], v[46:47], 1.0 op_sel_hi:[1,0]
    v_rcp_f32 v92, v92
    v_rcp_f32 v93, v93
    v_rcp_f32 v94, v94
    v_rcp_f32 v95, v95
    v_rcp_f32 v44, v44
    v_rcp_f32 v45, v45
    v_rcp_f32 v46, v46
    v_rcp_f32 v47, v47
    v_pk_add_f32 v[18:19], v[18:19], v[92:93]
    v_pk_add_f32 v[20:21], v[20:21], v[94:95]
    v_pk_add_f32 v[22:23], v[22:23], v[44:45]
    v_pk_add_f32 v[24:25], v[24:25], v[46:47]
    v_pk_fma_f32 v[26:27], v[96:97], v[92:93], v[26:27]
    v_pk_fma_f32 v[28:29], v[98:99], v[94:95], v[28:29]
    v_pk_fma_f32 v[30:31], v[48:49], v[44:45], v[30:31]
    v_pk_fma_f32 v[32:33], v[50:51], v[46:47], v[32:33]
    s_mov_b64 exec, -1
K_SRECN:
    s_add_u32 s20, s20, 1
    s_cmp_lt_u32 s20, s21
    s_cbranch_scc1 K_SREC
    s_branch K_SBLK
K_SSEGN:
    s_add_u32 s17, s17, 1
    s_cmp_lt_u32 s17, 256
    s_cbranch_scc1 K_SSEG
    s_branch K_EPI0
K_SNEXT:
    s_add_u32 s16, s16, 16
    s_cmp_lt_u32 s16, 25
    s_cbranch_scc1 K_SGRP
K_DONE:
K_END:
    s_endpgm
.section .rodata,"a"
.p2align 6
.amdhsa_kernel standalone__edge_featured_mpnn_gatedgcn__graph_kernel
  .amdhsa_next_free_vgpr 128
  .amdhsa_next_free_sgpr 102
  .amdhsa_accum_offset 128
  .amdhsa_group_segment_fixed_size 0
  .amdhsa_kernarg_size 96
  .amdhsa_user_sgpr_count 2
  .amdhsa_user_sgpr_kernarg_segment_ptr 1
  .amdhsa_system_sgpr_workgroup_id_x 1
.end_amdhsa_kernel
```
